```python
import torch

def _softmax(x, axis=-1):
    return torch.softmax(x, dim=axis)
def _gelu(x):
    return torch.nn.functional.gelu(x, approximate="tanh")
def _silu(x):
    return torch.nn.functional.silu(x)
def _sigmoid(x):
    return torch.sigmoid(x)
def _layernorm(x, axis=-1, eps=1e-5):
    m = x.mean(dim=axis, keepdim=True)
    v = x.var(dim=axis, keepdim=True, unbiased=False)
    return (x - m) / torch.sqrt(v + eps)
def _scatter_add(tgt, idx, src, axis=0):
    return tgt.clone().index_add_(axis, idx, src)
def _segment_sum(src, seg, n):
    out = torch.zeros((n,) + src.shape[1:], dtype=src.dtype)
    return out.index_add_(0, seg, src)
def _pad(x, pw):
    flat = tuple(v for pair in reversed(pw) for v in pair)
    return torch.nn.functional.pad(x, flat)

kernel_name = 'sequential_preLN__ssm_conv_s4d__mixer_s_mlp__prompt'

def setup_inputs():

    _w = (lambda a: (lambda t: t.to(torch.bfloat16) if t.is_floating_point() else t)(torch.as_tensor(a)))
    def _A_setup():
        Bsz, L, D, N = 1, 2048, 512, 128
        return {
            "u": _w((lambda *s: torch.randn(*s, dtype=torch.bfloat16) * 0.05)(Bsz, L, D)),
            "log_A_real": _w((lambda *s: torch.randn(*s, dtype=torch.bfloat16) * 6.4)(D, N) * 0.5),
            "A_imag": _w((lambda *s: torch.randn(*s, dtype=torch.bfloat16) * 0.05)(D, N) * 3.14),
            "C_real": _w((lambda *s: torch.randn(*s, dtype=torch.bfloat16) * 0.05)(D, N) / N ** 0.5),
            "C_imag": _w((lambda *s: torch.randn(*s, dtype=torch.bfloat16) * 0.05)(D, N) / N ** 0.5),
            "log_dt": _w((lambda *s: torch.randn(*s, dtype=torch.bfloat16) * 0.05)(D) * 0.5 - 4.0),
            "D_skip": _w((lambda *s: torch.randn(*s, dtype=torch.bfloat16) * 0.05)(D)),
        }
    _A_in = _A_setup()

    def _B_setup():
        B, S, D, F = 1, 2048, 512, 1376
        return {
            "x":  _w((lambda *s: torch.randn(*s, dtype=torch.bfloat16) * 0.05)(B, S, D)),
            "w1": _w((lambda *s: torch.randn(*s, dtype=torch.bfloat16) * 6.4)(D, D) * (D ** -0.5)),
            "w2": _w((lambda *s: torch.randn(*s, dtype=torch.bfloat16) * 6.4)(D, D) * (D ** -0.5)),
            "w3": _w((lambda *s: torch.randn(*s, dtype=torch.bfloat16) * 6.4)(D, F) * (D ** -0.5)),
            "w4": _w((lambda *s: torch.randn(*s, dtype=torch.bfloat16) * 6.4)(F, D) * (F ** -0.5)),
        }
    _B_in = _B_setup()

    return {
        "A_u": _A_in["u"],
        "A_log_A_real": _A_in["log_A_real"],
        "A_A_imag": _A_in["A_imag"],
        "A_C_real": _A_in["C_real"],
        "A_C_imag": _A_in["C_imag"],
        "A_log_dt": _A_in["log_dt"],
        "A_D_skip": _A_in["D_skip"],
        "B_x": _B_in["x"],
        "B_w1": _B_in["w1"],
        "B_w2": _B_in["w2"],
        "B_w3": _B_in["w3"],
        "B_w4": _B_in["w4"],
    }

def reference(A_u, A_log_A_real, A_A_imag, A_C_real, A_C_imag, A_log_dt, A_D_skip, B_x, B_w1, B_w2, B_w3, B_w4):
    def _A_ref(u, log_A_real, A_imag, C_real, C_imag, log_dt, D_skip):
        L = u.shape[1]
        dt = torch.exp(log_dt)
        A = -torch.exp(log_A_real) + 1j * A_imag
        C = (C_real + 1j * C_imag) * dt[:, None]
        pos = (lambda x, dt: x.to(dt))(torch.arange(L), log_dt.dtype)
        P = torch.exp((A * dt[:, None])[:, :, None] * pos[None, None, :])
        K = 2.0 * torch.einsum("dn,dnl->dl", C, P).real
        L2 = 2 * L
        u_t = (lambda x, *d: x.permute(*d))(u, 0, 2, 1)
        Kf = (lambda x, *a, **k: torch.fft.rfft(x.float(), *a, **k))(K, L2)
        Uf = (lambda x, *a, **k: torch.fft.rfft(x.float(), *a, **k))(u_t, L2)
        y = (lambda x, *a, **k: torch.fft.irfft(x, *a, **k).to(torch.bfloat16))(Uf * Kf[None, :, :], L2)[:, :, :L]
        y = (lambda x, *d: x.permute(*d))(y, 0, 2, 1)
        return y + u * D_skip[None, None, :]

    def _B_ref(x, w1, w2, w3, w4):
        B, S, D = x.shape
        h = _gelu(_layernorm(x, axis=-1) @ w1)
        c = D // 4
        g0 = _pad(h[:, :, 0*c:1*c], ((0, 0), (1, 0), (0, 0)))[:, :S, :]
        g1 = _pad(h[:, :, 1*c:2*c], ((0, 0), (0, 1), (0, 0)))[:, 1:, :]
        g2 = _pad(h[:, :, 2*c:3*c], ((0, 0), (2, 0), (0, 0)))[:, :S, :]
        g3 = _pad(h[:, :, 3*c:   ], ((0, 0), (0, 2), (0, 0)))[:, 2:, :]
        hs = torch.concatenate([g0, g1, g2, g3], axis=-1) @ w2
        x1 = x + hs
        h2 = _gelu(_layernorm(x1, axis=-1) @ w3) @ w4
        return x1 + h2

    x = A_u
    h = x + _A_ref(_layernorm(x, axis=-1), A_log_A_real, A_A_imag, A_C_real, A_C_imag, A_log_dt, A_D_skip)
    h2 = h + _B_ref(_layernorm(h, axis=-1), B_w1, B_w2, B_w3, B_w4)
    return h2
```

```asm
; @launch grid=(256,1,1) block=(256,1,1) lds=163840
.amdgcn_target "amdgcn-amd-amdhsa--gfx950"
.text
.globl sequential_preLN__ssm_conv_s4d__mixer_s_mlp__prompt_kernel
.p2align 8
.type sequential_preLN__ssm_conv_s4d__mixer_s_mlp__prompt_kernel,@function
sequential_preLN__ssm_conv_s4d__mixer_s_mlp__prompt_kernel:
  s_load_dwordx16 s[36:51], s[0:1], 0
  s_load_dwordx2 s[62:63], s[0:1], 112
  s_load_dwordx8 s[52:59], s[0:1], 64
  s_load_dwordx2 s[60:61], s[0:1], 96
  s_cmp_ge_u32 s2, 256
  s_cbranch_scc1 Lend
  s_lshr_b32 s65, s2, 3
  s_getpc_b64 s[74:75]
Lpc:
  s_add_u32 s74, s74, Lorg-Lpc
  s_addc_u32 s75, s75, 0
  v_lshrrev_b32 v30, 5, v0
  v_lshl_add_u32 v30, v30, 5, s65
  v_lshlrev_b32 v30, 7, v30
  v_min_u32 v30, Lcode_end-Lorg-4, v30
  global_load_dword v7, v30, s[74:75]
  v_and_b32 v1, 63, v0
  v_lshrrev_b32 v2, 6, v0
  s_and_b32 s64, s2, 7
  v_lshlrev_b32 v3, 4, v1
  v_readfirstlane_b32 s3, v2
  v_lshl_add_u32 v4, v2, 11, v3
  s_mov_b32 s14, 0x200000
  s_mov_b32 s15, 0x20000
  s_lshl_b32 s4, s64, 5
  s_add_u32 s4, s4, s65
  s_lshl_b32 s67, s2, 13
  s_lshl_b32 s5, s64, 2
  s_lshr_b32 s66, s2, 6
  s_add_u32 s5, s5, s66
  s_and_b32 s6, s65, 7
  v_lshlrev_b32 v5, 4, v0
  s_lshl_b32 s66, s4, 9
  v_lshl_add_u32 v6, v0, 1, s66
  s_lshl_b32 s66, s4, 2
  s_mov_b32 s10, 34603008
  s_mov_b32 s11, 0x20000
  v_mov_b32 v8, -1
  v_mov_b32 v9, -1
  v_mov_b32 v10, -1
  v_mov_b32 v11, -1
  s_mov_b32 s18, 0x80000
  s_mov_b32 s19, 0x20000
  s_mov_b32 s22, 0x80000
  s_mov_b32 s23, 0x20000
  s_mov_b32 s26, 1409024
  s_mov_b32 s27, 0x20000
  s_mov_b32 s30, 1409024
  s_mov_b32 s31, 0x20000
  s_waitcnt lgkmcnt(0)
  s_mov_b32 s12, s36
  s_mov_b32 s13, s37
  buffer_load_dwordx4 v[32:35], v4, s[12:15], s67 offen nt
  buffer_load_dwordx4 v[36:39], v4, s[12:15], s67 offen offset:1024 nt
  s_mov_b64 s[8:9], s[62:63]
  s_load_dword s7, s[8:9], 0
  v_mov_b32 v44, s66
  s_mov_b64 s[16:17], s[52:53]
  s_mov_b64 s[20:21], s[54:55]
  s_mov_b64 s[24:25], s[56:57]
  s_mov_b64 s[28:29], s[58:59]
  s_mov_b64 s[32:33], s[60:61]
  s_barrier
  v_mov_b32 v45, v6
  global_load_ushort v40, v45, s[38:39] nt
  global_load_ushort v41, v45, s[40:41] nt
  global_load_ushort v42, v45, s[42:43] nt
  global_load_ushort v43, v45, s[44:45] nt
  global_load_dword v46, v44, s[46:47]
  global_load_dword v47, v44, s[48:49]
  s_branch Lorg
.p2align 12
Lorg:
  v_mov_b32 v68, 0x3f803f80
  v_mov_b32 v64, 0
  v_mov_b32 v65, 0
  v_mov_b32 v66, 0
  v_mov_b32 v67, 0
  s_mul_i32 s64, s3, 2080
  s_add_u32 s64, s64, 100352
  v_add_u32 v13, s64, v3
  v_and_b32 v14, 3, v0
  v_mul_u32_u24 v14, 2080, v14
  v_and_b32 v15, 0xfc, v0
  v_add_u32 v14, v14, v15
  v_add_u32 v14, 100352, v14
  v_add_u32 v12, 4096, v5
  v_lshrrev_b32 v15, 1, v1
  s_mul_i32 s68, s2, 16512
  s_add_u32 s68, s68, 1048576
  s_add_u32 s69, s68, 8192
  s_add_u32 s66, s68, 16384
  s_lshl_b32 s67, s3, 4
  s_add_u32 s67, s67, 108672
  v_add_u32 v15, s67, v15
  s_mov_b32 s70, 0
  s_mov_b32 s73, 0xffff0000
  v_and_b32 v20, 15, v1
  v_lshrrev_b32 v21, 4, v1
  s_mul_i32 s64, s3, 8704
  s_add_u32 s64, s64, 65536
  v_lshl_add_u32 v16, v1, 2, s64
  v_and_b32 v30, 31, v1
  s_mov_b32 s65, 0x77f80000
  v_bfe_u32 v17, s65, v30, 1
  s_mov_b32 s65, 0x6407f0f0
  v_bfe_u32 v31, s65, v30, 1
  v_lshl_add_u32 v17, v17, 1, v31
  s_mov_b32 s65, 0x13878f00
  v_bfe_u32 v31, s65, v30, 1
  v_lshl_add_u32 v17, v17, 1, v31
  s_mov_b32 s65, 0x524e7c8c
  v_bfe_u32 v31, s65, v30, 1
  v_lshl_add_u32 v17, v17, 1, v31
  s_mov_b32 s65, 0x22ad4a4a
  v_bfe_u32 v31, s65, v30, 1
  v_lshl_add_u32 v17, v17, 1, v31
  v_lshrrev_b32 v31, 5, v1
  v_lshl_add_u32 v31, v31, 4, s64
  s_movk_i32 s65, 272
  v_mad_u32_u24 v17, v17, s65, v31
  v_mad_u32_u24 v18, v30, s65, v31
  s_cmp_lt_u32 s6, 6
  s_cselect_b32 s63, 22, 20
  s_mul_i32 s62, s3, 6
  s_sub_u32 s63, s63, s62
  v_bfrev_b32 v25, 1
  v_add_u32 v30, 0, v1
  v_mul_u32_u24 v31, 10923, v30
  v_lshrrev_b32 v31, 16, v31
  v_mad_i32_i24 v30, v31, -6, v30
  v_mul_u32_u24 v31, 2656, v31
  v_lshl_add_u32 v22, v1, 4, v31
  v_cmp_le_u32 vcc, s63, v30
  s_nop 1
  v_cndmask_b32 v22, v22, v25, vcc
  v_add_u32 v30, 64, v1
  v_mul_u32_u24 v31, 10923, v30
  v_lshrrev_b32 v31, 16, v31
  v_mad_i32_i24 v30, v31, -6, v30
  v_mul_u32_u24 v31, 2656, v31
  v_lshl_add_u32 v23, v1, 4, v31
  v_cmp_le_u32 vcc, s63, v30
  s_nop 1
  v_cndmask_b32 v23, v23, v25, vcc
  v_add_u32 v30, 128, v1
  v_mul_u32_u24 v31, 10923, v30
  v_lshrrev_b32 v31, 16, v31
  v_mad_i32_i24 v30, v31, -6, v30
  v_mul_u32_u24 v31, 2656, v31
  v_lshl_add_u32 v24, v1, 4, v31
  v_cmp_le_u32 vcc, s63, v30
  s_nop 1
  v_cndmask_b32 v24, v24, v25, vcc
  s_lshl_b32 s60, s3, 14
  s_mul_i32 s61, s3, 6144
  s_add_u32 s61, s61, 110592
  s_mul_i32 s62, s6, 352
  s_min_u32 s62, s62, 2432
  s_mul_i32 s63, s3, 96
  s_add_u32 s62, s62, s63
  s_and_b32 s81, s5, 1
  s_mul_i32 s63, s81, 0
  s_sub_u32 s76, s62, s63
  s_add_u32 s62, s62, s63
  v_lshrrev_b32 v30, 2, v1
  v_mul_u32_u24 v30, 96, v30
  v_and_b32 v31, 3, v1
  v_lshl_add_u32 v30, v31, 3, v30
  v_add_u32 v25, s60, v30
  v_add_u32 v19, s61, v30
  s_waitcnt lgkmcnt(0)
  s_add_u32 s7, s7, 0x9E3779B9
  v_mov_b32 v73, -1
  v_mov_b32 v75, s7
  v_mov_b32 v77, -1
  v_mov_b32 v79, s7
  v_mov_b32 v81, -1
  v_mov_b32 v83, s7
  v_mov_b32 v85, -1
  v_mov_b32 v87, s7
  v_mov_b32 v71, s7
  s_waitcnt vmcnt(6)
  ds_write_b128 v13, v[32:35]
  ds_write_b128 v13, v[36:39] offset:1040
  v_dot2c_f32_bf16 v64, v32, v68
  v_dot2c_f32_bf16 v66, v32, v32
  v_dot2c_f32_bf16 v65, v36, v68
  v_dot2c_f32_bf16 v67, v36, v36
  v_dot2c_f32_bf16 v64, v33, v68
  v_dot2c_f32_bf16 v66, v33, v33
  v_dot2c_f32_bf16 v65, v37, v68
  v_dot2c_f32_bf16 v67, v37, v37
  v_dot2c_f32_bf16 v64, v34, v68
  v_dot2c_f32_bf16 v66, v34, v34
  v_dot2c_f32_bf16 v65, v38, v68
  v_dot2c_f32_bf16 v67, v38, v38
  v_dot2c_f32_bf16 v64, v35, v68
  v_dot2c_f32_bf16 v66, v35, v35
  v_dot2c_f32_bf16 v65, v39, v68
  v_dot2c_f32_bf16 v67, v39, v39
  s_waitcnt lgkmcnt(0)
  s_barrier
  ds_read_b32 v72, v14 offset:0
  ds_read_b32 v74, v14 offset:1040
  ds_read_b32 v76, v14 offset:256
  ds_read_b32 v78, v14 offset:1296
  ds_read_b32 v80, v14 offset:512
  ds_read_b32 v82, v14 offset:1552
  ds_read_b32 v84, v14 offset:768
  ds_read_b32 v86, v14 offset:1808
  v_permlane32_swap_b32 v64, v66
  v_permlane32_swap_b32 v65, v67
  v_add_f32 v64, v64, v66
  v_add_f32 v65, v65, v67
  s_nop 1
  v_permlane16_swap_b32 v64, v65
  s_nop 0
  v_add_f32 v64, v64, v65
  s_waitcnt lgkmcnt(6)
  buffer_store_dwordx4 v[72:75], v5, s[8:11], s68 offen sc1
  v_add_f32_dpp v64, v64, v64 quad_perm:[1,0,3,2] row_mask:0xf bank_mask:0xf
  s_waitcnt lgkmcnt(4)
  buffer_store_dwordx4 v[76:79], v12, s[8:11], s68 offen sc1
  v_add_f32_dpp v64, v64, v64 quad_perm:[2,3,0,1] row_mask:0xf bank_mask:0xf
  s_waitcnt lgkmcnt(2)
  buffer_store_dwordx4 v[80:83], v5, s[8:11], s69 offen sc1
  v_add_f32_dpp v64, v64, v64 row_half_mirror row_mask:0xf bank_mask:0xf
  s_waitcnt lgkmcnt(0)
  buffer_store_dwordx4 v[84:87], v12, s[8:11], s69 offen sc1
  v_add_f32_dpp v64, v64, v64 row_mirror row_mask:0xf bank_mask:0xf
  v_mul_f32 v64, 0x3b000000, v64
  v_mov_b32 v66, v64
  s_nop 1
  v_permlane32_swap_b32 v64, v66
  s_nop 0
  v_fma_f32 v66, -v64, v64, v66
  v_max_f32 v66, 0, v66
  v_add_f32 v66, 0x3727c5ac, v66
  v_rsq_f32 v66, v66
  s_mov_b64 exec, 0x10001
  v_cvt_pk_bf16_f32 v70, v66, -v64
  ds_write_b64 v15, v[70:71]
  s_mov_b64 exec, -1
  v_and_b32 v15, 0x30, v3
  v_add_u32 v15, 108672, v15
  s_waitcnt lgkmcnt(0)
  s_barrier
  s_cmp_lg_u32 s3, 0
  s_cbranch_scc1 Lst1
  s_mov_b64 exec, 255
  ds_read_b128 v[88:91], v15
  s_waitcnt lgkmcnt(0)
  buffer_store_dwordx4 v[88:91], v3, s[8:11], s66 offen sc1
  s_mov_b64 exec, -1
Lst1:
  s_nop 1
  s_mul_i32 s58, s2, 5504
  v_min_u32 v6, 42, v0
  v_lshlrev_b32 v6, 7, v6
  buffer_load_dword v7, v6, s[24:27], s58 offen
  s_waitcnt vmcnt(5)
  v_readfirstlane_b32 s71, v46
  v_readfirstlane_b32 s72, v47
  s_lshl_b32 s64, s71, 16
  s_and_b32 s65, s71, 0xffff0000
  s_cmp_lt_u32 s3, 2
  s_cselect_b32 s64, s64, s65
  v_mov_b32 v44, 0x3fb8aa3b
  v_mul_f32 v44, s64, v44
  v_exp_f32 v44, v44
  v_lshlrev_b32 v40, 16, v40
  v_lshlrev_b32 v41, 16, v41
  v_lshlrev_b32 v42, 16, v42
  v_lshlrev_b32 v43, 16, v43
  v_mul_f32 v40, 0x3fb8aa3b, v40
  v_exp_f32 v40, v40
  v_cvt_pk_bf16_f32 v44, v44, v44
  v_lshlrev_b32 v44, 16, v44
  v_cvt_pk_bf16_f32 v40, v40, v40
  v_lshlrev_b32 v40, 16, v40
  v_mul_f32 v47, v41, v44
  v_mul_f32 v46, v40, v44
  v_add_f32 v44, v44, v44
  v_mul_f32 v46, 0xbfb8aa3b, v46
  v_mul_f32 v47, 0.15915494, v47
  v_mul_f32 v48, v42, v44
  v_mul_f32 v49, v43, v44
  v_mul_f32 v32, 0x41000000, v46
  s_mul_i32 s58, s4, 8448
  s_add_u32 s58, s58, 6291456
  buffer_store_dwordx4 v[8:11], v5, s[8:11], s58 offen sc1
  v_mul_f32 v33, 0xc1000000, v47
  v_mul_f32 v34, 0x3f800000, v46
  v_mul_f32 v35, 0x3f800000, v47
  v_mul_f32 v36, 0x43800000, v46
  v_mul_f32 v37, 0x43800000, v47
  v_fract_f32 v33, v33
  v_exp_f32 v32, v32
  v_fract_f32 v35, v35
  v_exp_f32 v34, v34
  v_fract_f32 v37, v37
  v_exp_f32 v36, v36
  v_cos_f32 v112, v33
  v_sin_f32 v113, v33
  v_cos_f32 v66, v35
  v_sin_f32 v67, v35
  v_cos_f32 v72, v37
  v_sin_f32 v73, v37
  v_mov_b32 v86, 0x3f80
  v_pk_mul_f32 v[112:113], v[112:113], v[32:33] op_sel_hi:[1,0]
  v_pk_mul_f32 v[66:67], v[66:67], v[34:35] op_sel_hi:[1,0]
  v_pk_mul_f32 v[72:73], v[72:73], v[36:37] op_sel_hi:[1,0]
.p2align 3
  v_cvt_pk_bf16_f32 v87, v112, v113
  v_pk_mul_f32 v[32:33], v[112:113], v[112:113] op_sel:[1,1] op_sel_hi:[1,0]
  v_pk_fma_f32 v[114:115], v[112:113], v[112:113], v[32:33] op_sel:[0,0,0] op_sel_hi:[0,1,1] neg_lo:[0,0,1]
  v_cvt_pk_bf16_f32 v88, v114, v115
  v_pk_mul_f32 v[32:33], v[114:115], v[112:113] op_sel:[1,1] op_sel_hi:[1,0]
  v_pk_fma_f32 v[116:117], v[114:115], v[112:113], v[32:33] op_sel:[0,0,0] op_sel_hi:[0,1,1] neg_lo:[0,0,1]
  v_cvt_pk_bf16_f32 v89, v116, v117
  ds_write2_b32 v16, v86, v87 offset0:0 offset1:68
  ds_write2_b32 v16, v88, v89 offset0:136 offset1:204
  v_pk_mul_f32 v[32:33], v[114:115], v[114:115] op_sel:[1,1] op_sel_hi:[1,0]
  v_pk_fma_f32 v[118:119], v[114:115], v[114:115], v[32:33] op_sel:[0,0,0] op_sel_hi:[0,1,1] neg_lo:[0,0,1]
  v_cvt_pk_bf16_f32 v90, v118, v119
  v_pk_mul_f32 v[32:33], v[118:119], v[112:113] op_sel:[1,1] op_sel_hi:[1,0]
  v_pk_fma_f32 v[120:121], v[118:119], v[112:113], v[32:33] op_sel:[0,0,0] op_sel_hi:[0,1,1] neg_lo:[0,0,1]
  v_cvt_pk_bf16_f32 v91, v120, v121
  v_pk_mul_f32 v[32:33], v[118:119], v[114:115] op_sel:[1,1] op_sel_hi:[1,0]
  v_pk_fma_f32 v[122:123], v[118:119], v[114:115], v[32:33] op_sel:[0,0,0] op_sel_hi:[0,1,1] neg_lo:[0,0,1]
  v_cvt_pk_bf16_f32 v92, v122, v123
  v_pk_mul_f32 v[32:33], v[118:119], v[116:117] op_sel:[1,1] op_sel_hi:[1,0]
  v_add_u32 v15, 1088, v16
  v_pk_fma_f32 v[124:125], v[118:119], v[116:117], v[32:33] op_sel:[0,0,0] op_sel_hi:[0,1,1] neg_lo:[0,0,1]
  v_cvt_pk_bf16_f32 v93, v124, v125
  ds_write2_b32 v15, v90, v91 offset0:0 offset1:68
  ds_write2_b32 v15, v92, v93 offset0:136 offset1:204
  v_pk_mul_f32 v[32:33], v[118:119], v[118:119] op_sel:[1,1] op_sel_hi:[1,0]
  v_pk_fma_f32 v[126:127], v[118:119], v[118:119], v[32:33] op_sel:[0,0,0] op_sel_hi:[0,1,1] neg_lo:[0,0,1]
  v_cvt_pk_bf16_f32 v86, v126, v127
  v_pk_mul_f32 v[32:33], v[126:127], v[112:113] op_sel:[1,1] op_sel_hi:[1,0]
  v_pk_fma_f32 v[128:129], v[126:127], v[112:113], v[32:33] op_sel:[0,0,0] op_sel_hi:[0,1,1] neg_lo:[0,0,1]
  v_cvt_pk_bf16_f32 v87, v128, v129
  v_pk_mul_f32 v[32:33], v[126:127], v[114:115] op_sel:[1,1] op_sel_hi:[1,0]
  v_pk_fma_f32 v[130:131], v[126:127], v[114:115], v[32:33] op_sel:[0,0,0] op_sel_hi:[0,1,1] neg_lo:[0,0,1]
  v_cvt_pk_bf16_f32 v88, v130, v131
  v_pk_mul_f32 v[32:33], v[126:127], v[116:117] op_sel:[1,1] op_sel_hi:[1,0]
  v_add_u32 v15, 2176, v16
  v_pk_fma_f32 v[132:133], v[126:127], v[116:117], v[32:33] op_sel:[0,0,0] op_sel_hi:[0,1,1] neg_lo:[0,0,1]
  v_cvt_pk_bf16_f32 v89, v132, v133
  ds_write2_b32 v15, v86, v87 offset0:0 offset1:68
  ds_write2_b32 v15, v88, v89 offset0:136 offset1:204
  v_pk_mul_f32 v[32:33], v[126:127], v[118:119] op_sel:[1,1] op_sel_hi:[1,0]
  v_pk_fma_f32 v[134:135], v[126:127], v[118:119], v[32:33] op_sel:[0,0,0] op_sel_hi:[0,1,1] neg_lo:[0,0,1]
  v_cvt_pk_bf16_f32 v90, v134, v135
  v_pk_mul_f32 v[32:33], v[126:127], v[120:121] op_sel:[1,1] op_sel_hi:[1,0]
  v_pk_fma_f32 v[136:137], v[126:127], v[120:121], v[32:33] op_sel:[0,0,0] op_sel_hi:[0,1,1] neg_lo:[0,0,1]
  v_cvt_pk_bf16_f32 v91, v136, v137
  v_pk_mul_f32 v[32:33], v[126:127], v[122:123] op_sel:[1,1] op_sel_hi:[1,0]
  v_pk_fma_f32 v[138:139], v[126:127], v[122:123], v[32:33] op_sel:[0,0,0] op_sel_hi:[0,1,1] neg_lo:[0,0,1]
  v_cvt_pk_bf16_f32 v92, v138, v139
  v_pk_mul_f32 v[32:33], v[126:127], v[124:125] op_sel:[1,1] op_sel_hi:[1,0]
  v_add_u32 v15, 3264, v16
  v_pk_fma_f32 v[140:141], v[126:127], v[124:125], v[32:33] op_sel:[0,0,0] op_sel_hi:[0,1,1] neg_lo:[0,0,1]
  v_cvt_pk_bf16_f32 v93, v140, v141
  ds_write2_b32 v15, v90, v91 offset0:0 offset1:68
  ds_write2_b32 v15, v92, v93 offset0:136 offset1:204
  v_pk_mul_f32 v[32:33], v[126:127], v[126:127] op_sel:[1,1] op_sel_hi:[1,0]
  v_pk_fma_f32 v[142:143], v[126:127], v[126:127], v[32:33] op_sel:[0,0,0] op_sel_hi:[0,1,1] neg_lo:[0,0,1]
  v_cvt_pk_bf16_f32 v86, v142, v143
  v_pk_mul_f32 v[32:33], v[142:143], v[112:113] op_sel:[1,1] op_sel_hi:[1,0]
  v_pk_fma_f32 v[112:113], v[142:143], v[112:113], v[32:33] op_sel:[0,0,0] op_sel_hi:[0,1,1] neg_lo:[0,0,1]
  v_cvt_pk_bf16_f32 v87, v112, v113
  v_pk_mul_f32 v[32:33], v[142:143], v[114:115] op_sel:[1,1] op_sel_hi:[1,0]
  v_pk_fma_f32 v[114:115], v[142:143], v[114:115], v[32:33] op_sel:[0,0,0] op_sel_hi:[0,1,1] neg_lo:[0,0,1]
  v_cvt_pk_bf16_f32 v88, v114, v115
  s_add_u32 s58, s58, 4224
  buffer_store_dwordx4 v[8:11], v5, s[8:11], s58 offen sc1
  v_pk_mul_f32 v[32:33], v[142:143], v[116:117] op_sel:[1,1] op_sel_hi:[1,0]
  v_add_u32 v15, 4352, v16
  v_pk_fma_f32 v[116:117], v[142:143], v[116:117], v[32:33] op_sel:[0,0,0] op_sel_hi:[0,1,1] neg_lo:[0,0,1]
  v_cvt_pk_bf16_f32 v89, v116, v117
  ds_write2_b32 v15, v86, v87 offset0:0 offset1:68
  ds_write2_b32 v15, v88, v89 offset0:136 offset1:204
  v_pk_mul_f32 v[32:33], v[142:143], v[118:119] op_sel:[1,1] op_sel_hi:[1,0]
  v_pk_fma_f32 v[118:119], v[142:143], v[118:119], v[32:33] op_sel:[0,0,0] op_sel_hi:[0,1,1] neg_lo:[0,0,1]
  v_cvt_pk_bf16_f32 v90, v118, v119
  v_pk_mul_f32 v[32:33], v[142:143], v[120:121] op_sel:[1,1] op_sel_hi:[1,0]
  v_pk_fma_f32 v[120:121], v[142:143], v[120:121], v[32:33] op_sel:[0,0,0] op_sel_hi:[0,1,1] neg_lo:[0,0,1]
  v_cvt_pk_bf16_f32 v91, v120, v121
  v_pk_mul_f32 v[32:33], v[142:143], v[122:123] op_sel:[1,1] op_sel_hi:[1,0]
  v_pk_fma_f32 v[122:123], v[142:143], v[122:123], v[32:33] op_sel:[0,0,0] op_sel_hi:[0,1,1] neg_lo:[0,0,1]
  v_cvt_pk_bf16_f32 v92, v122, v123
  v_pk_mul_f32 v[32:33], v[142:143], v[124:125] op_sel:[1,1] op_sel_hi:[1,0]
  v_add_u32 v15, 5440, v16
  v_pk_fma_f32 v[124:125], v[142:143], v[124:125], v[32:33] op_sel:[0,0,0] op_sel_hi:[0,1,1] neg_lo:[0,0,1]
  v_cvt_pk_bf16_f32 v93, v124, v125
  ds_write2_b32 v15, v90, v91 offset0:0 offset1:68
  ds_write2_b32 v15, v92, v93 offset0:136 offset1:204
  v_pk_mul_f32 v[32:33], v[142:143], v[126:127] op_sel:[1,1] op_sel_hi:[1,0]
  v_pk_fma_f32 v[126:127], v[142:143], v[126:127], v[32:33] op_sel:[0,0,0] op_sel_hi:[0,1,1] neg_lo:[0,0,1]
  v_cvt_pk_bf16_f32 v86, v126, v127
  v_pk_mul_f32 v[32:33], v[142:143], v[128:129] op_sel:[1,1] op_sel_hi:[1,0]
  v_pk_fma_f32 v[128:129], v[142:143], v[128:129], v[32:33] op_sel:[0,0,0] op_sel_hi:[0,1,1] neg_lo:[0,0,1]
  v_cvt_pk_bf16_f32 v87, v128, v129
  v_pk_mul_f32 v[32:33], v[142:143], v[130:131] op_sel:[1,1] op_sel_hi:[1,0]
  v_pk_fma_f32 v[130:131], v[142:143], v[130:131], v[32:33] op_sel:[0,0,0] op_sel_hi:[0,1,1] neg_lo:[0,0,1]
  v_cvt_pk_bf16_f32 v88, v130, v131
  v_pk_mul_f32 v[32:33], v[142:143], v[132:133] op_sel:[1,1] op_sel_hi:[1,0]
  v_add_u32 v15, 6528, v16
  v_pk_fma_f32 v[132:133], v[142:143], v[132:133], v[32:33] op_sel:[0,0,0] op_sel_hi:[0,1,1] neg_lo:[0,0,1]
  v_cvt_pk_bf16_f32 v89, v132, v133
  ds_write2_b32 v15, v86, v87 offset0:0 offset1:68
  ds_write2_b32 v15, v88, v89 offset0:136 offset1:204
  v_pk_mul_f32 v[32:33], v[142:143], v[134:135] op_sel:[1,1] op_sel_hi:[1,0]
  v_pk_fma_f32 v[134:135], v[142:143], v[134:135], v[32:33] op_sel:[0,0,0] op_sel_hi:[0,1,1] neg_lo:[0,0,1]
  v_cvt_pk_bf16_f32 v90, v134, v135
  v_pk_mul_f32 v[32:33], v[142:143], v[136:137] op_sel:[1,1] op_sel_hi:[1,0]
  v_pk_fma_f32 v[136:137], v[142:143], v[136:137], v[32:33] op_sel:[0,0,0] op_sel_hi:[0,1,1] neg_lo:[0,0,1]
  v_cvt_pk_bf16_f32 v91, v136, v137
  v_pk_mul_f32 v[32:33], v[142:143], v[138:139] op_sel:[1,1] op_sel_hi:[1,0]
  v_pk_fma_f32 v[138:139], v[142:143], v[138:139], v[32:33] op_sel:[0,0,0] op_sel_hi:[0,1,1] neg_lo:[0,0,1]
  v_cvt_pk_bf16_f32 v92, v138, v139
  v_pk_mul_f32 v[32:33], v[142:143], v[140:141] op_sel:[1,1] op_sel_hi:[1,0]
  v_add_u32 v15, 7616, v16
  v_pk_fma_f32 v[140:141], v[142:143], v[140:141], v[32:33] op_sel:[0,0,0] op_sel_hi:[0,1,1] neg_lo:[0,0,1]
  v_cvt_pk_bf16_f32 v93, v140, v141
  ds_write2_b32 v15, v90, v91 offset0:0 offset1:68
  ds_write2_b32 v15, v92, v93 offset0:136 offset1:204
  v_pk_mul_f32 v[32:33], v[66:67], v[66:67] op_sel:[1,1] op_sel_hi:[1,0]
  v_pk_fma_f32 v[68:69], v[66:67], v[66:67], v[32:33] op_sel:[0,0,0] op_sel_hi:[0,1,1] neg_lo:[0,0,1]
  v_pk_mul_f32 v[32:33], v[48:49], v[66:67] op_sel:[1,1] op_sel_hi:[1,0]
  v_pk_fma_f32 v[50:51], v[48:49], v[66:67], v[32:33] op_sel:[0,0,0] op_sel_hi:[0,1,1] neg_lo:[0,0,1]
  v_pk_mul_f32 v[32:33], v[68:69], v[68:69] op_sel:[1,1] op_sel_hi:[1,0]
  v_pk_fma_f32 v[70:71], v[68:69], v[68:69], v[32:33] op_sel:[0,0,0] op_sel_hi:[0,1,1] neg_lo:[0,0,1]
  v_pk_mul_f32 v[32:33], v[48:49], v[68:69] op_sel:[1,1] op_sel_hi:[1,0]
  v_pk_fma_f32 v[52:53], v[48:49], v[68:69], v[32:33] op_sel:[0,0,0] op_sel_hi:[0,1,1] neg_lo:[0,0,1]
  s_waitcnt lgkmcnt(0)
  ds_read_b128 a[128:131], v18 offset:0
  ds_read_b128 a[132:135], v18 offset:32
  ds_read_b128 a[136:139], v18 offset:64
  ds_read_b128 a[140:143], v18 offset:96
  ds_read_b128 a[144:147], v18 offset:128
  ds_read_b128 a[148:151], v18 offset:160
  ds_read_b128 a[152:155], v18 offset:192
  ds_read_b128 a[156:159], v18 offset:224
.p2align 3
  v_pk_mul_f32 v[32:33], v[50:51], v[68:69] op_sel:[1,1] op_sel_hi:[1,0]
  v_pk_fma_f32 v[54:55], v[50:51], v[68:69], v[32:33] op_sel:[0,0,0] op_sel_hi:[0,1,1] neg_lo:[0,0,1]
  v_pk_mul_f32 v[32:33], v[48:49], v[70:71] op_sel:[1,1] op_sel_hi:[1,0]
  v_pk_fma_f32 v[56:57], v[48:49], v[70:71], v[32:33] op_sel:[0,0,0] op_sel_hi:[0,1,1] neg_lo:[0,0,1]
  v_pk_mul_f32 v[32:33], v[50:51], v[70:71] op_sel:[1,1] op_sel_hi:[1,0]
  v_pk_fma_f32 v[58:59], v[50:51], v[70:71], v[32:33] op_sel:[0,0,0] op_sel_hi:[0,1,1] neg_lo:[0,0,1]
  v_pk_mul_f32 v[32:33], v[52:53], v[70:71] op_sel:[1,1] op_sel_hi:[1,0]
  v_pk_fma_f32 v[60:61], v[52:53], v[70:71], v[32:33] op_sel:[0,0,0] op_sel_hi:[0,1,1] neg_lo:[0,0,1]
  v_pk_mul_f32 v[32:33], v[54:55], v[70:71] op_sel:[1,1] op_sel_hi:[1,0]
  v_pk_fma_f32 v[62:63], v[54:55], v[70:71], v[32:33] op_sel:[0,0,0] op_sel_hi:[0,1,1] neg_lo:[0,0,1]
  v_pk_mul_f32 v[32:33], v[56:57], v[70:71] op_sel:[1,1] op_sel_hi:[1,0]
  v_pk_fma_f32 v[64:65], v[56:57], v[70:71], v[32:33] op_sel:[0,0,0] op_sel_hi:[0,1,1] neg_lo:[0,0,1]
  v_pk_mul_f32 v[32:33], v[72:73], v[72:73] op_sel:[1,1] op_sel_hi:[1,0]
  v_pk_fma_f32 v[74:75], v[72:73], v[72:73], v[32:33] op_sel:[0,0,0] op_sel_hi:[0,1,1] neg_lo:[0,0,1]
  v_pk_mul_f32 v[32:33], v[74:75], v[72:73] op_sel:[1,1] op_sel_hi:[1,0]
  v_pk_fma_f32 v[76:77], v[74:75], v[72:73], v[32:33] op_sel:[0,0,0] op_sel_hi:[0,1,1] neg_lo:[0,0,1]
  v_pk_mul_f32 v[32:33], v[74:75], v[74:75] op_sel:[1,1] op_sel_hi:[1,0]
  v_pk_fma_f32 v[78:79], v[74:75], v[74:75], v[32:33] op_sel:[0,0,0] op_sel_hi:[0,1,1] neg_lo:[0,0,1]
  v_pk_mul_f32 v[32:33], v[78:79], v[72:73] op_sel:[1,1] op_sel_hi:[1,0]
  v_pk_fma_f32 v[80:81], v[78:79], v[72:73], v[32:33] op_sel:[0,0,0] op_sel_hi:[0,1,1] neg_lo:[0,0,1]
  v_pk_mul_f32 v[32:33], v[78:79], v[74:75] op_sel:[1,1] op_sel_hi:[1,0]
  v_pk_fma_f32 v[82:83], v[78:79], v[74:75], v[32:33] op_sel:[0,0,0] op_sel_hi:[0,1,1] neg_lo:[0,0,1]
  v_pk_mul_f32 v[32:33], v[78:79], v[76:77] op_sel:[1,1] op_sel_hi:[1,0]
  v_pk_fma_f32 v[84:85], v[78:79], v[76:77], v[32:33] op_sel:[0,0,0] op_sel_hi:[0,1,1] neg_lo:[0,0,1]
  s_barrier
  s_waitcnt lgkmcnt(0)
  s_add_u32 m0, s60, 0
  s_add_u32 s63, s62, 0
  buffer_load_dwordx4 v22, s[24:27], s63 offen lds
.p2align 3
  v_cvt_pk_bf16_f32 v86, v48, v49
  v_cvt_pk_bf16_f32 v87, v50, v51
  v_cvt_pk_bf16_f32 v88, v52, v53
  v_cvt_pk_bf16_f32 v89, v54, v55
  ds_write2_b32 v16, v86, v87 offset0:0 offset1:68
  ds_write2_b32 v16, v88, v89 offset0:136 offset1:204
  v_cvt_pk_bf16_f32 v90, v56, v57
  v_cvt_pk_bf16_f32 v91, v58, v59
  v_add_u32 v15, 1088, v16
  v_cvt_pk_bf16_f32 v92, v60, v61
  v_cvt_pk_bf16_f32 v93, v62, v63
  ds_write2_b32 v15, v90, v91 offset0:0 offset1:68
  ds_write2_b32 v15, v92, v93 offset0:136 offset1:204
  v_pk_mul_f32 v[32:33], v[72:73], v[48:49] op_sel:[1,1] op_sel_hi:[1,0]
  buffer_load_dwordx4 v23, s[24:27], s63 offen offset:1024 lds
  v_pk_fma_f32 v[34:35], v[72:73], v[48:49], v[32:33] op_sel:[0,0,0] op_sel_hi:[0,1,1] neg_lo:[0,0,1]
  v_cvt_pk_bf16_f32 v86, v34, v35
  v_pk_mul_f32 v[32:33], v[72:73], v[52:53] op_sel:[1,1] op_sel_hi:[1,0]
  v_pk_fma_f32 v[34:35], v[72:73], v[52:53], v[32:33] op_sel:[0,0,0] op_sel_hi:[0,1,1] neg_lo:[0,0,1]
  v_cvt_pk_bf16_f32 v87, v34, v35
  v_pk_mul_f32 v[32:33], v[72:73], v[56:57] op_sel:[1,1] op_sel_hi:[1,0]
  v_pk_fma_f32 v[34:35], v[72:73], v[56:57], v[32:33] op_sel:[0,0,0] op_sel_hi:[0,1,1] neg_lo:[0,0,1]
  v_cvt_pk_bf16_f32 v88, v34, v35
  v_pk_mul_f32 v[32:33], v[72:73], v[60:61] op_sel:[1,1] op_sel_hi:[1,0]
  v_add_u32 v15, 2176, v16
  v_pk_fma_f32 v[34:35], v[72:73], v[60:61], v[32:33] op_sel:[0,0,0] op_sel_hi:[0,1,1] neg_lo:[0,0,1]
  v_cvt_pk_bf16_f32 v89, v34, v35
  ds_write2_b32 v15, v86, v87 offset0:0 offset1:68
  ds_write2_b32 v15, v88, v89 offset0:136 offset1:204
  buffer_load_dwordx4 v24, s[24:27], s63 offen offset:2048 lds
  v_pk_mul_f32 v[32:33], v[72:73], v[64:65] op_sel:[1,1] op_sel_hi:[1,0]
  v_pk_fma_f32 v[34:35], v[72:73], v[64:65], v[32:33] op_sel:[0,0,0] op_sel_hi:[0,1,1] neg_lo:[0,0,1]
  v_cvt_pk_bf16_f32 v90, v34, v35
  v_pk_mul_f32 v[32:33], v[74:75], v[48:49] op_sel:[1,1] op_sel_hi:[1,0]
  v_pk_fma_f32 v[34:35], v[74:75], v[48:49], v[32:33] op_sel:[0,0,0] op_sel_hi:[0,1,1] neg_lo:[0,0,1]
  v_cvt_pk_bf16_f32 v91, v34, v35
  v_pk_mul_f32 v[32:33], v[74:75], v[56:57] op_sel:[1,1] op_sel_hi:[1,0]
  v_pk_fma_f32 v[34:35], v[74:75], v[56:57], v[32:33] op_sel:[0,0,0] op_sel_hi:[0,1,1] neg_lo:[0,0,1]
  v_cvt_pk_bf16_f32 v92, v34, v35
  v_pk_mul_f32 v[32:33], v[74:75], v[64:65] op_sel:[1,1] op_sel_hi:[1,0]
  v_add_u32 v15, 3264, v16
  v_pk_fma_f32 v[34:35], v[74:75], v[64:65], v[32:33] op_sel:[0,0,0] op_sel_hi:[0,1,1] neg_lo:[0,0,1]
  v_cvt_pk_bf16_f32 v93, v34, v35
  s_add_u32 m0, s60, 3072
  s_add_u32 s63, s62, 88064
  buffer_load_dwordx4 v22, s[24:27], s63 offen lds
  ds_write2_b32 v15, v90, v91 offset0:0 offset1:68
  ds_write2_b32 v15, v92, v93 offset0:136 offset1:204
  v_pk_mul_f32 v[32:33], v[76:77], v[48:49] op_sel:[1,1] op_sel_hi:[1,0]
  v_pk_fma_f32 v[34:35], v[76:77], v[48:49], v[32:33] op_sel:[0,0,0] op_sel_hi:[0,1,1] neg_lo:[0,0,1]
  v_cvt_pk_bf16_f32 v86, v34, v35
  v_pk_mul_f32 v[32:33], v[76:77], v[56:57] op_sel:[1,1] op_sel_hi:[1,0]
  v_pk_fma_f32 v[34:35], v[76:77], v[56:57], v[32:33] op_sel:[0,0,0] op_sel_hi:[0,1,1] neg_lo:[0,0,1]
  v_cvt_pk_bf16_f32 v87, v34, v35
  v_pk_mul_f32 v[32:33], v[76:77], v[64:65] op_sel:[1,1] op_sel_hi:[1,0]
  v_pk_fma_f32 v[34:35], v[76:77], v[64:65], v[32:33] op_sel:[0,0,0] op_sel_hi:[0,1,1] neg_lo:[0,0,1]
  v_cvt_pk_bf16_f32 v88, v34, v35
  v_pk_mul_f32 v[32:33], v[78:79], v[48:49] op_sel:[1,1] op_sel_hi:[1,0]
  v_add_u32 v15, 4352, v16
  v_pk_fma_f32 v[34:35], v[78:79], v[48:49], v[32:33] op_sel:[0,0,0] op_sel_hi:[0,1,1] neg_lo:[0,0,1]
  buffer_load_dwordx4 v23, s[24:27], s63 offen offset:1024 lds
  v_cvt_pk_bf16_f32 v89, v34, v35
  ds_write2_b32 v15, v86, v87 offset0:0 offset1:68
  ds_write2_b32 v15, v88, v89 offset0:136 offset1:204
  v_pk_mul_f32 v[32:33], v[78:79], v[64:65] op_sel:[1,1] op_sel_hi:[1,0]
  v_pk_fma_f32 v[34:35], v[78:79], v[64:65], v[32:33] op_sel:[0,0,0] op_sel_hi:[0,1,1] neg_lo:[0,0,1]
  v_cvt_pk_bf16_f32 v90, v34, v35
  v_pk_mul_f32 v[32:33], v[80:81], v[48:49] op_sel:[1,1] op_sel_hi:[1,0]
  v_pk_fma_f32 v[34:35], v[80:81], v[48:49], v[32:33] op_sel:[0,0,0] op_sel_hi:[0,1,1] neg_lo:[0,0,1]
  v_cvt_pk_bf16_f32 v91, v34, v35
  v_pk_mul_f32 v[32:33], v[80:81], v[64:65] op_sel:[1,1] op_sel_hi:[1,0]
  v_pk_fma_f32 v[34:35], v[80:81], v[64:65], v[32:33] op_sel:[0,0,0] op_sel_hi:[0,1,1] neg_lo:[0,0,1]
  v_cvt_pk_bf16_f32 v92, v34, v35
  v_pk_mul_f32 v[32:33], v[82:83], v[48:49] op_sel:[1,1] op_sel_hi:[1,0]
  v_add_u32 v15, 5440, v16
  buffer_load_dwordx4 v24, s[24:27], s63 offen offset:2048 lds
  v_pk_fma_f32 v[34:35], v[82:83], v[48:49], v[32:33] op_sel:[0,0,0] op_sel_hi:[0,1,1] neg_lo:[0,0,1]
  v_cvt_pk_bf16_f32 v93, v34, v35
  ds_write2_b32 v15, v90, v91 offset0:0 offset1:68
  ds_write2_b32 v15, v92, v93 offset0:136 offset1:204
  v_pk_mul_f32 v[32:33], v[82:83], v[64:65] op_sel:[1,1] op_sel_hi:[1,0]
  v_pk_fma_f32 v[34:35], v[82:83], v[64:65], v[32:33] op_sel:[0,0,0] op_sel_hi:[0,1,1] neg_lo:[0,0,1]
  v_cvt_pk_bf16_f32 v86, v34, v35
  v_pk_mul_f32 v[32:33], v[84:85], v[48:49] op_sel:[1,1] op_sel_hi:[1,0]
  v_pk_fma_f32 v[34:35], v[84:85], v[48:49], v[32:33] op_sel:[0,0,0] op_sel_hi:[0,1,1] neg_lo:[0,0,1]
  v_cvt_pk_bf16_f32 v87, v34, v35
  v_pk_mul_f32 v[32:33], v[84:85], v[64:65] op_sel:[1,1] op_sel_hi:[1,0]
  v_pk_fma_f32 v[34:35], v[84:85], v[64:65], v[32:33] op_sel:[0,0,0] op_sel_hi:[0,1,1] neg_lo:[0,0,1]
  v_cvt_pk_bf16_f32 v88, v34, v35
  ds_write_b32 v16, v86 offset:6528
  ds_write_b32 v16, v87 offset:6800
  ds_write_b32 v16, v88 offset:7072
  v_lshrrev_b32 v30, 2, v0
  v_and_b32 v2, 3, v0
  v_lshlrev_b32 v2, 4, v2
  s_movk_i32 s68, 16512
  v_mad_u32_u24 v2, v30, s68, v2
  s_waitcnt vmcnt(9)
  s_lshl_b32 s68, s4, 6
  s_mov_b32 s69, 1064960
  buffer_load_dwordx4 v[112:115], v2, s[8:11], s69 offen sc1
  s_mov_b32 s69, 2121728
  buffer_load_dwordx4 v[116:119], v2, s[8:11], s69 offen sc1
  s_mov_b32 s69, 3178496
  buffer_load_dwordx4 v[120:123], v2, s[8:11], s69 offen sc1
  s_mov_b32 s69, 4235264
  buffer_load_dwordx4 v[124:127], v2, s[8:11], s69 offen sc1
  s_waitcnt lgkmcnt(0)
  ds_read_b128 a[96:99], v17 offset:0
  ds_read_b128 a[100:103], v17 offset:32
  ds_read_b128 a[104:107], v17 offset:64
  ds_read_b128 a[108:111], v17 offset:96
  ds_read_b128 a[112:115], v17 offset:128
  ds_read_b128 a[116:119], v17 offset:160
  ds_read_b128 a[120:123], v17 offset:192
  ds_read_b128 a[124:127], v17 offset:224
  s_lshl_b32 s64, s3, 11
  s_add_u32 s65, s64, 109568
  v_add_u32 v32, s65, v3
  s_xor_b32 s64, s64, 2048
  s_add_u32 s65, s64, 109568
  v_add_u32 v33, s65, v3
  s_lshr_b32 s64, s3, 1
  s_waitcnt lgkmcnt(7)
  v_mfma_f32_32x32x16_bf16 v[48:63], a[96:99], a[128:131], 0
  s_mul_i32 s66, s64, 16640
  s_add_u32 s67, s66, 69616
  v_sub_u32 v34, s67, v3
  v_and_b32 v35, 1, v1
  s_waitcnt lgkmcnt(6)
  v_mfma_f32_32x32x16_bf16 v[48:63], a[100:103], a[132:135], v[48:63]
  v_cmp_eq_u32 vcc, 1, v35
  v_mov_b32 v36, 0
  v_mov_b32 v40, 0
  s_lshl_b32 s67, s64, 4
  s_waitcnt lgkmcnt(5)
  v_mfma_f32_32x32x16_bf16 v[48:63], a[104:107], a[136:139], v[48:63]
  s_lshr_b32 s67, s72, s67
  s_lshl_b32 s67, s67, 16
  v_writelane_b32 v40, s67, 0
  v_lshlrev_b32 v13, 2, v0
  s_waitcnt lgkmcnt(4)
  v_mfma_f32_32x32x16_bf16 v[48:63], a[108:111], a[140:143], v[48:63]
  v_and_b32 v37, 0x1ff, v13
  s_mul_i32 s67, s64, 4608
  s_add_u32 s67, s67, 100352
  v_add_u32 v37, s67, v37
  s_waitcnt lgkmcnt(3)
  v_mfma_f32_32x32x16_bf16 v[48:63], a[112:115], a[144:147], v[48:63]
  v_add_u32 v13, 100864, v13
  v_and_b32 v38, 15, v0
  v_bfe_u32 v39, v0, 4, 3
  v_mul_u32_u24 v39, 4160, v39
  s_waitcnt lgkmcnt(2)
  v_mfma_f32_32x32x16_bf16 v[48:63], a[116:119], a[148:151], v[48:63]
  v_lshl_add_u32 v38, v38, 2, v39
  v_add_u32 v38, 69632, v38
  s_and_b32 s65, s3, 1
  v_and_b32 v16, 3, v20
  s_waitcnt lgkmcnt(1)
  v_mfma_f32_32x32x16_bf16 v[48:63], a[120:123], a[152:155], v[48:63]
  v_sub_u32 v16, 3, v16
  v_mul_u32_u24 v16, 4160, v16
  v_lshlrev_b32 v30, 1, v21
  v_lshrrev_b32 v31, 2, v20
  s_waitcnt lgkmcnt(0)
  v_mfma_f32_32x32x16_bf16 v[48:63], a[124:127], a[156:159], v[48:63]
  v_sub_u32 v30, v30, v31
  v_lshl_add_u32 v16, v30, 3, v16
  s_lshl_b32 s68, s65, 8
  s_sub_u32 s66, s66, s68
  s_add_u32 s66, s66, 65816
  v_add_u32 v16, s66, v16
  v_lshlrev_b32 v14, 5, v20
  v_lshl_add_u32 v14, v21, 4, v14
  s_sub_u32 s67, s67, s68
  s_add_u32 s67, s67, 288
  v_add_u32 v14, s67, v14
  s_mov_b64 exec, 0
  s_branch Lpage1
Lback1:
  s_mov_b64 exec, -1
  s_mov_b64 exec, 0
  s_branch Lpage2
Lback2:
  s_mov_b64 exec, -1
  s_mov_b64 exec, 0
  s_branch Lpage3
Lback3:
  s_mov_b64 exec, -1
  s_mov_b64 exec, 0
  s_branch Lpage4
Lback4:
  s_mov_b64 exec, -1
  s_mov_b64 exec, 0
  s_branch Lpage5
Lback5:
  s_mov_b64 exec, -1
  s_mov_b64 exec, 0
  s_branch Lpage6
Lback6:
  s_mov_b64 exec, -1
  s_waitcnt vmcnt(0)
  s_mov_b64 s[0:1], vcc
  v_xor_b32 v30, s7, v113
  v_bitop3_b32 v30, v30, s7, v117 bitop3:0xf6
  v_bitop3_b32 v30, v30, s7, v121 bitop3:0xf6
  v_bitop3_b32 v30, v30, s7, v125 bitop3:0xf6
  v_cmp_ne_u32 vcc, 0, v30
  s_cbranch_vccnz Lretry2
Lcont3:
  s_mov_b64 vcc, s[0:1]
  s_lshl_b32 s68, s4, 6
  s_add_u32 s69, s68, 1048576
  buffer_load_dwordx4 v[96:99], v2, s[8:11], s69 offen sc1
  s_add_u32 s69, s68, 2105344
  buffer_load_dwordx4 v[100:103], v2, s[8:11], s69 offen sc1
  s_add_u32 s69, s68, 3162112
  buffer_load_dwordx4 v[104:107], v2, s[8:11], s69 offen sc1
  s_add_u32 s69, s68, 4218880
  buffer_load_dwordx4 v[108:111], v2, s[8:11], s69 offen sc1
  ds_write_b32 v37, v36
  s_cmp_eq_u32 s65, 1
Lpage1:
  s_cbranch_execz Lback1
  s_cbranch_scc1 Lkh4
  s_nop 3
  ds_write_b128 v32, v[56:59]
  ds_write_b128 v32, v[60:63] offset:1024
  v_add_f32 v48, v48, v40
  s_waitcnt lgkmcnt(0)
  s_barrier
  ds_read_b128 v[64:67], v33
  ds_read_b128 v[68:71], v33 offset:1024
  ds_write_b32 v38, v36
  s_waitcnt lgkmcnt(1)
  v_pk_add_f32 v[48:49], v[48:49], v[64:65]
  v_pk_add_f32 v[50:51], v[50:51], v[66:67]
  v_pk_add_f32 v[52:53], v[52:53], v[68:69]
  v_pk_add_f32 v[54:55], v[54:55], v[70:71]
  v_cvt_pk_bf16_f32 v72, v55, v54
  v_cvt_pk_bf16_f32 v73, v53, v52
  v_cvt_pk_bf16_f32 v74, v51, v50
  v_cvt_pk_bf16_f32 v75, v49, v48
  ds_write_b128 v34, v[72:75]
  s_branch Lkj5
Lkh4:
  s_nop 3
  ds_write_b128 v32, v[48:51]
  ds_write_b128 v32, v[52:55] offset:1024
  s_waitcnt lgkmcnt(0)
  s_barrier
  ds_read_b128 v[64:67], v33
  ds_read_b128 v[68:71], v33 offset:1024
  ds_write_b32 v38, v36
  v_subrev_u32 v34, 3072, v34
  s_waitcnt lgkmcnt(1)
  v_pk_add_f32 v[56:57], v[56:57], v[64:65]
  v_pk_add_f32 v[58:59], v[58:59], v[66:67]
  v_pk_add_f32 v[60:61], v[60:61], v[68:69]
  v_pk_add_f32 v[62:63], v[62:63], v[70:71]
  v_cvt_pk_bf16_f32 v72, v58, v58
  v_cvt_pk_bf16_f32 v73, v57, v57
  v_cvt_pk_bf16_f32 v74, v57, v56
  v_cvt_pk_bf16_f32 v75, v56, v56
  ds_write_b128 v34, v[72:75] offset:2048
  v_cndmask_b32 v64, v59, v60, vcc
  v_cvt_pk_bf16_f32 v76, v60, v60
  v_cvt_pk_bf16_f32 v77, v60, v64
  v_cvt_pk_bf16_f32 v78, v59, v59
  v_cvt_pk_bf16_f32 v79, v59, v59
  ds_write_b128 v34, v[76:79] offset:1024
  v_cndmask_b32 v64, v61, v62, vcc
  v_cvt_pk_bf16_f32 v80, v62, v62
  v_cvt_pk_bf16_f32 v81, v62, v64
  v_cvt_pk_bf16_f32 v82, v61, v61
  v_cvt_pk_bf16_f32 v83, v61, v61
  ds_write_b128 v34, v[80:83] offset:0
Lkj5:
  v_add_u32 v32, 65536, v5
  s_waitcnt lgkmcnt(0)
  s_barrier
  ds_read_b128 v[48:51], v32 offset:0
  ds_read_b64 v[52:53], v32 offset:16
  ds_read_b128 v[56:59], v32 offset:16640
  ds_read_b64 v[60:61], v32 offset:16656
  v_lshrrev_b32 v30, 3, v1
  v_mul_u32_u24 v30, 1024, v30
  v_and_b32 v31, 7, v1
  v_lshlrev_b32 v26, 1, v21
  v_xor_b32 v31, v31, v26
  v_lshl_add_u32 v26, v31, 4, v30
  v_add_u32 v27, 7168, v26
  v_add_u32 v28, 63488, v26
  v_add_u32 v29, 70656, v26
  v_subrev_u32 v15, 88576, v13
  s_add_u32 m0, s60, 6144
  s_add_u32 s63, s62, 176128
  buffer_load_dwordx4 v22, s[24:27], s63 offen lds
  s_waitcnt lgkmcnt(2)
  v_alignbit_b32 v64, v49, v48, 16
  v_alignbit_b32 v65, v50, v49, 16
  v_alignbit_b32 v66, v51, v50, 16
  v_alignbit_b32 v67, v52, v51, 16
  ds_write_b128 v32, v[64:67] offset:4160
  v_pk_mov_b32 v[68:69], v[48:49], v[50:51] op_sel:[1,0]
  buffer_load_dwordx4 v23, s[24:27], s63 offen offset:1024 lds
  v_pk_mov_b32 v[70:71], v[50:51], v[52:53] op_sel:[1,0]
  ds_write_b128 v32, v[68:71] offset:8320
  v_alignbit_b32 v72, v50, v49, 16
  v_alignbit_b32 v73, v51, v50, 16
  v_alignbit_b32 v74, v52, v51, 16
  v_alignbit_b32 v75, v53, v52, 16
  ds_write_b128 v32, v[72:75] offset:12480
  buffer_load_dwordx4 v24, s[24:27], s63 offen offset:2048 lds
  s_waitcnt lgkmcnt(3)
  v_alignbit_b32 v76, v57, v56, 16
  v_alignbit_b32 v77, v58, v57, 16
  v_alignbit_b32 v78, v59, v58, 16
  v_alignbit_b32 v79, v60, v59, 16
  ds_write_b128 v32, v[76:79] offset:20800
  v_pk_mov_b32 v[80:81], v[56:57], v[58:59] op_sel:[1,0]
  s_add_u32 m0, s60, 9216
  s_add_u32 s63, s62, 264192
  buffer_load_dwordx4 v22, s[24:27], s63 offen lds
  v_pk_mov_b32 v[82:83], v[58:59], v[60:61] op_sel:[1,0]
  ds_write_b128 v32, v[80:83] offset:24960
  v_alignbit_b32 v84, v58, v57, 16
  v_alignbit_b32 v85, v59, v58, 16
  v_alignbit_b32 v86, v60, v59, 16
  v_alignbit_b32 v87, v61, v60, 16
  ds_write_b128 v32, v[84:87] offset:29120
  buffer_load_dwordx4 v23, s[24:27], s63 offen offset:1024 lds
  s_waitcnt vmcnt(5)
  v_xor_b32 v30, s7, v99
  v_bitop3_b32 v30, v30, s7, v103 bitop3:0xf6
  v_bitop3_b32 v30, v30, s7, v107 bitop3:0xf6
  v_bitop3_b32 v30, v30, s7, v111 bitop3:0xf6
  v_bitop3_b32 v30, v30, s7, v115 bitop3:0xf6
  v_bitop3_b32 v30, v30, s7, v119 bitop3:0xf6
  v_bitop3_b32 v30, v30, s7, v123 bitop3:0xf6
  v_bitop3_b32 v30, v30, s7, v127 bitop3:0xf6
  v_cmp_ne_u32 vcc, 0, v30
  s_cbranch_vccnz Lretry6
Lcont7:
  v_lshlrev_b32 v128, 16, v96
  v_lshlrev_b32 v129, 16, v98
  v_and_b32 v130, s73, v96
  v_and_b32 v131, s73, v98
  v_lshlrev_b32 v113, 16, v114
  v_and_b32 v115, s73, v114
  buffer_load_dwordx4 v24, s[24:27], s63 offen offset:2048 lds
  v_and_b32 v114, s73, v112
  v_lshlrev_b32 v112, 16, v112
  v_pk_mul_f32 v[114:115], v[114:115], v[112:113]
  v_pk_fma_f32 v[96:97], v[128:129], v[112:113], v[114:115]
  v_pk_fma_f32 v[98:99], v[130:131], v[112:113], v[114:115]
  v_cvt_pk_bf16_f32 v96, v96, v97
  v_cvt_pk_bf16_f32 v97, v98, v99
  s_add_u32 m0, s61, 24576
  s_add_u32 s63, s76, 352256
  buffer_load_dwordx4 v22, s[24:27], s63 offen lds
  v_cvt_pk_bf16_f32 v128, v128, v129
  v_cvt_pk_bf16_f32 v129, v130, v131
  v_lshlrev_b32 v132, 16, v100
  v_lshlrev_b32 v133, 16, v102
  v_and_b32 v134, s73, v100
  v_and_b32 v135, s73, v102
  v_lshlrev_b32 v117, 16, v118
  buffer_load_dwordx4 v23, s[24:27], s63 offen offset:1024 lds
  v_and_b32 v119, s73, v118
  v_and_b32 v118, s73, v116
  v_lshlrev_b32 v116, 16, v116
  v_pk_mul_f32 v[118:119], v[118:119], v[116:117]
  v_pk_fma_f32 v[100:101], v[132:133], v[116:117], v[118:119]
  v_pk_fma_f32 v[102:103], v[134:135], v[116:117], v[118:119]
  v_cvt_pk_bf16_f32 v100, v100, v101
  buffer_load_dwordx4 v24, s[24:27], s63 offen offset:2048 lds
  v_cvt_pk_bf16_f32 v101, v102, v103
  v_cvt_pk_bf16_f32 v132, v132, v133
  v_cvt_pk_bf16_f32 v133, v134, v135
  ds_write2st64_b32 v13, v96, v97 offset0:0 offset1:18
  ds_write2st64_b32 v15, v128, v129 offset0:0 offset1:128
  ds_write2st64_b32 v13, v100, v101 offset0:4 offset1:22
  ds_write2st64_b32 v15, v132, v133 offset0:4 offset1:132
  v_lshlrev_b32 v136, 16, v104
  v_lshlrev_b32 v137, 16, v106
  v_and_b32 v138, s73, v104
  s_mul_i32 s58, s2, 2048
  v_min_u32 v6, 15, v0
  v_lshlrev_b32 v6, 7, v6
  buffer_load_dword v7, v6, s[16:19], s58 offen
  v_and_b32 v139, s73, v106
  v_lshlrev_b32 v121, 16, v122
  v_and_b32 v123, s73, v122
  v_and_b32 v122, s73, v120
  v_lshlrev_b32 v120, 16, v120
  v_pk_mul_f32 v[122:123], v[122:123], v[120:121]
  v_pk_fma_f32 v[104:105], v[136:137], v[120:121], v[122:123]
  s_mul_i32 s58, s2, 2048
  v_min_u32 v6, 15, v0
  v_lshlrev_b32 v6, 7, v6
  buffer_load_dword v7, v6, s[20:23], s58 offen
  v_pk_fma_f32 v[106:107], v[138:139], v[120:121], v[122:123]
  v_cvt_pk_bf16_f32 v104, v104, v105
  v_cvt_pk_bf16_f32 v105, v106, v107
  v_cvt_pk_bf16_f32 v136, v136, v137
  v_cvt_pk_bf16_f32 v137, v138, v139
  v_lshlrev_b32 v140, 16, v108
  v_lshlrev_b32 v141, 16, v110
  s_lshr_b32 s58, s2, 3
  s_mul_i32 s58, s58, 16384
  s_sub_u32 s59, 384, s16
  s_and_b32 s59, s59, 896
  s_add_u32 s58, s58, s59
  v_min_u32 v6, 15, v0
  v_lshlrev_b32 v6, 10, v6
  buffer_load_dword v7, v6, s[16:19], s58 offen
  v_and_b32 v142, s73, v108
  v_and_b32 v143, s73, v110
  v_lshlrev_b32 v125, 16, v126
  v_and_b32 v127, s73, v126
  v_and_b32 v126, s73, v124
  v_lshlrev_b32 v124, 16, v124
  v_pk_mul_f32 v[126:127], v[126:127], v[124:125]
  s_lshr_b32 s58, s2, 3
  s_mul_i32 s58, s58, 16384
  s_sub_u32 s59, 384, s20
  s_and_b32 s59, s59, 896
  s_add_u32 s58, s58, s59
  v_min_u32 v6, 15, v0
  v_lshlrev_b32 v6, 10, v6
  buffer_load_dword v7, v6, s[20:23], s58 offen
  v_pk_fma_f32 v[108:109], v[140:141], v[124:125], v[126:127]
  v_pk_fma_f32 v[110:111], v[142:143], v[124:125], v[126:127]
  v_cvt_pk_bf16_f32 v108, v108, v109
  v_cvt_pk_bf16_f32 v109, v110, v111
  v_cvt_pk_bf16_f32 v140, v140, v141
  v_cvt_pk_bf16_f32 v141, v142, v143
  ds_write2st64_b32 v13, v104, v105 offset0:8 offset1:26
  ds_write2st64_b32 v15, v136, v137 offset0:64 offset1:192
  ds_write2st64_b32 v13, v108, v109 offset0:12 offset1:30
  ds_write2st64_b32 v15, v140, v141 offset0:68 offset1:196
  s_waitcnt lgkmcnt(0)
  s_barrier
  ds_read_b64 a[0:1], v16 offset:3776
  ds_read_b64 a[2:3], v16 offset:3784
  ds_read_b128 v[64:67], v14 offset:192
  ds_read_b128 v[68:71], v14 offset:704
  ds_read_b128 v[72:75], v14 offset:1216
  ds_read_b128 v[76:79], v14 offset:1728
  s_waitcnt lgkmcnt(3)
  v_mfma_f32_16x16x32_bf16 v[96:99], a[0:3], v[64:67], 0
  s_waitcnt lgkmcnt(2)
  s_add_u32 m0, s61, 0
  ds_read_b128 v[80:83], v14 offset:2240
  v_mfma_f32_16x16x32_bf16 v[100:103], a[0:3], v[68:71], 0
  s_waitcnt lgkmcnt(2)
  s_add_u32 s63, s76, 440320
  ds_read_b128 v[84:87], v14 offset:2752
  buffer_load_dwordx4 v22, s[24:27], s63 offen lds
  v_mfma_f32_16x16x32_bf16 v[104:107], a[0:3], v[72:75], 0
  s_waitcnt lgkmcnt(2)
  ds_read_b128 v[88:91], v14 offset:3264
  s_cmp_lg_u32 s3, 0
  s_cbranch_scc1 Lep8
  v_mov_b32 v30, s7
  s_lshl_b32 s68, s2, 4
  s_add_u32 s68, s68, 24576
  s_mov_b64 exec, 1
  buffer_store_dword v30, off, s[8:11], s68 sc1
  s_cmp_lg_u32 s2, 0
  s_cbranch_scc1 Lep8
  buffer_store_dword v30, off, s[8:11], 0 sc1
Lep8:
  s_mov_b64 exec, -1
  v_mfma_f32_16x16x32_bf16 v[108:111], a[0:3], v[76:79], 0
  s_waitcnt lgkmcnt(2)
  ds_read_b128 v[92:95], v14 offset:3776
  v_mfma_f32_16x16x32_bf16 v[112:115], a[0:3], v[80:83], 0
  s_waitcnt lgkmcnt(2)
  ds_read_b64 a[4:5], v16 offset:3264
  ds_read_b64_tr_b16 a[176:177], v25 offset:0
  v_mfma_f32_16x16x32_bf16 v[116:119], a[0:3], v[84:87], 0
  s_waitcnt lgkmcnt(3)
  ds_read_b64 a[6:7], v16 offset:3272
  ds_read_b64_tr_b16 a[178:179], v25 offset:1536
  v_mfma_f32_16x16x32_bf16 v[120:123], a[0:3], v[88:91], 0
  s_waitcnt lgkmcnt(4)
  ds_read_b64 a[8:9], v16 offset:2752
  buffer_load_dwordx4 v23, s[24:27], s63 offen offset:1024 lds
  ds_read_b64_tr_b16 a[180:181], v25 offset:32
  v_mfma_f32_16x16x32_bf16 v[124:127], a[0:3], v[92:95], 0
  s_waitcnt lgkmcnt(3)
  ds_read_b64 a[10:11], v16 offset:2760
  ds_read_b128 v[92:95], v14 offset:3712
  v_mfma_f32_16x16x32_bf16 v[100:103], a[4:7], v[64:67], v[100:103]
  ds_read_b64 a[12:13], v16 offset:2240
  ds_read_b64_tr_b16 a[182:183], v25 offset:1568
  v_mfma_f32_16x16x32_bf16 v[104:107], a[4:7], v[68:71], v[104:107]
  ds_read_b64 a[14:15], v16 offset:2248
  ds_read_b64_tr_b16 a[184:185], v25 offset:64
  v_mfma_f32_16x16x32_bf16 v[108:111], a[4:7], v[72:75], v[108:111]
  ds_read_b64 a[16:17], v16 offset:1728
  ds_read_b64_tr_b16 a[186:187], v25 offset:1600
  v_mfma_f32_16x16x32_bf16 v[112:115], a[4:7], v[76:79], v[112:115]
  ds_read_b64 a[18:19], v16 offset:1736
  buffer_load_dwordx4 v24, s[24:27], s63 offen offset:2048 lds
  v_mfma_f32_16x16x32_bf16 v[116:119], a[4:7], v[80:83], v[116:119]
  ds_read_b64 a[20:21], v16 offset:1216
  ds_read_b64_tr_b16 a[188:189], v25 offset:3072
  v_mfma_f32_16x16x32_bf16 v[120:123], a[4:7], v[84:87], v[120:123]
  ds_read_b64 a[22:23], v16 offset:1224
  ds_read_b64_tr_b16 a[190:191], v25 offset:4608
  s_add_u32 m0, s61, 3072
  v_mfma_f32_16x16x32_bf16 v[124:127], a[4:7], v[88:91], v[124:127]
  s_waitcnt lgkmcnt(12)
  ds_read_b64 a[24:25], v16 offset:704
  ds_read_b128 v[88:91], v14 offset:3200
  v_mfma_f32_16x16x32_bf16 v[104:107], a[8:11], v[64:67], v[104:107]
  ds_read_b64 a[26:27], v16 offset:712
  ds_read_b64_tr_b16 a[192:193], v25 offset:3104
  s_add_u32 s63, s76, 528384
  v_mfma_f32_16x16x32_bf16 v[108:111], a[8:11], v[68:71], v[108:111]
  ds_read_b64 a[28:29], v16 offset:192
  ds_read_b64_tr_b16 a[194:195], v25 offset:4640
  buffer_load_dwordx4 v22, s[24:27], s63 offen lds
  v_mfma_f32_16x16x32_bf16 v[112:115], a[8:11], v[72:75], v[112:115]
  ds_read_b64 a[30:31], v16 offset:200
  ds_read_b64_tr_b16 a[196:197], v25 offset:3136
  v_mfma_f32_16x16x32_bf16 v[116:119], a[8:11], v[76:79], v[116:119]
  ds_read_b64_tr_b16 a[198:199], v25 offset:4672
  ds_read_b64 a[32:33], v16 offset:3712
  v_mfma_f32_16x16x32_bf16 v[120:123], a[8:11], v[80:83], v[120:123]
  s_waitcnt vmcnt(14)
  ds_read_b64_tr_b16 a[200:201], v25 offset:6144
  ds_read_b64 a[34:35], v16 offset:3720
  v_mfma_f32_16x16x32_bf16 v[124:127], a[8:11], v[84:87], v[124:127]
  s_waitcnt lgkmcnt(14)
  ds_read_b128 v[84:87], v14 offset:2688
  ds_read_b64 a[36:37], v16 offset:3200
  v_mfma_f32_16x16x32_bf16 v[108:111], a[12:15], v[64:67], v[108:111]
  buffer_load_dwordx4 v23, s[24:27], s63 offen offset:1024 lds
  v_mfma_f32_16x16x32_bf16 v[112:115], a[12:15], v[68:71], v[112:115]
  ds_read_b64_tr_b16 a[202:203], v25 offset:7680
  ds_read_b64 a[38:39], v16 offset:3208
  v_mfma_f32_16x16x32_bf16 v[116:119], a[12:15], v[72:75], v[116:119]
  ds_read_b64_tr_b16 a[204:205], v25 offset:6176
  ds_read_b64 a[40:41], v16 offset:2688
  v_mfma_f32_16x16x32_bf16 v[120:123], a[12:15], v[76:79], v[120:123]
  ds_read_b64 a[42:43], v16 offset:2696
  ds_read_b64_tr_b16 a[206:207], v25 offset:7712
  v_lshlrev_b32 v17, 5, v20
  v_mfma_f32_16x16x32_bf16 v[124:127], a[12:15], v[80:83], v[124:127]
  s_waitcnt lgkmcnt(14)
  ds_read_b128 v[80:83], v14 offset:2176
  ds_read_b64 a[44:45], v16 offset:2176
  v_mfma_f32_16x16x32_bf16 v[112:115], a[16:19], v[64:67], v[112:115]
  ds_read_b64_tr_b16 a[208:209], v25 offset:6208
  buffer_load_dwordx4 v24, s[24:27], s63 offen offset:2048 lds
  v_lshl_add_u32 v17, v21, 3, v17
  v_mfma_f32_16x16x32_bf16 v[116:119], a[16:19], v[68:71], v[116:119]
  ds_read_b64 a[46:47], v16 offset:2184
  ds_read_b64_tr_b16 a[210:211], v25 offset:7744
  v_mfma_f32_16x16x32_bf16 v[120:123], a[16:19], v[72:75], v[120:123]
  ds_read_b64 a[48:49], v16 offset:1664
  ds_read_b64 a[50:51], v16 offset:1672
  v_mfma_f32_16x16x32_bf16 v[124:127], a[16:19], v[76:79], v[124:127]
  s_waitcnt lgkmcnt(14)
  ds_read_b128 v[76:79], v14 offset:1664
  s_waitcnt vmcnt(13)
  ds_read_b64_tr_b16 a[212:213], v25 offset:9216
  v_add_u32 v17, s60, v17
  v_mfma_f32_16x16x32_bf16 v[116:119], a[20:23], v[64:67], v[116:119]
  ds_read_b64 a[52:53], v16 offset:1152
  ds_read_b64_tr_b16 a[214:215], v25 offset:10752
  s_add_u32 m0, s61, 27648
  v_mfma_f32_16x16x32_bf16 v[120:123], a[20:23], v[68:71], v[120:123]
  ds_read_b64 a[54:55], v16 offset:1160
  ds_read_b64 a[56:57], v16 offset:640
  ds_read_b64 a[58:59], v16 offset:648
  ds_read_b64 a[60:61], v16 offset:128
  ds_read_b64 a[62:63], v16 offset:136
  v_mfma_f32_16x16x32_bf16 v[124:127], a[20:23], v[72:75], v[124:127]
  s_waitcnt lgkmcnt(14)
  ds_read_b128 v[72:75], v14 offset:1152
  ds_read_b64_tr_b16 a[216:217], v25 offset:9248
  ds_read_b64 v[32:33], v17 offset:12288
  v_mfma_f32_16x16x32_bf16 v[120:123], a[24:27], v[64:67], v[120:123]
  ds_read_b64_tr_b16 a[218:219], v25 offset:10784
  s_add_u32 s63, s76, 616448
  buffer_load_dwordx4 v22, s[24:27], s63 offen lds
  v_mfma_f32_16x16x32_bf16 v[124:127], a[24:27], v[68:71], v[124:127]
  s_waitcnt lgkmcnt(14)
  ds_read_b128 v[68:71], v14 offset:640
  ds_read_b64_tr_b16 a[220:221], v25 offset:9280
  v_mfma_f32_16x16x32_bf16 v[124:127], a[28:31], v[64:67], v[124:127]
  s_waitcnt lgkmcnt(6)
  ds_read_b128 v[64:67], v14 offset:128
  ds_read_b64 v[34:35], v17 offset:12800
  v_mfma_f32_16x16x32_bf16 v[124:127], a[32:35], v[92:95], v[124:127]
  ds_read_b128 v[92:95], v14 offset:3648
  ds_read_b64_tr_b16 a[222:223], v25 offset:10816
  v_mfma_f32_16x16x32_bf16 v[120:123], a[32:35], v[88:91], v[120:123]
  buffer_load_dwordx4 v23, s[24:27], s63 offen offset:1024 lds
  s_waitcnt vmcnt(12)
  ds_read_b64_tr_b16 a[224:225], v19 offset:24576
  v_mfma_f32_16x16x32_bf16 v[124:127], a[36:39], v[88:91], v[124:127]
  ds_read_b128 v[88:91], v14 offset:3136
  ds_read_b64 v[36:37], v17 offset:13312
  v_mfma_f32_16x16x32_bf16 v[116:119], a[32:35], v[84:87], v[116:119]
  ds_read_b64 v[38:39], v17 offset:13824
  ds_read_b64_tr_b16 a[226:227], v19 offset:26112
  v_mfma_f32_16x16x32_bf16 v[120:123], a[36:39], v[84:87], v[120:123]
  ds_read_b64 a[64:65], v16 offset:3648
  ds_read_b64_tr_b16 a[228:229], v19 offset:24608
  v_mfma_f32_16x16x32_bf16 v[124:127], a[40:43], v[84:87], v[124:127]
  ds_read_b128 v[84:87], v14 offset:2624
  ds_read_b64_tr_b16 a[230:231], v19 offset:26144
  ds_read_b64_tr_b16 a[232:233], v19 offset:24640
  ds_read_b64_tr_b16 a[234:235], v19 offset:26176
  ds_read_b64 a[66:67], v16 offset:3656
  v_mfma_f32_16x16x32_bf16 v[112:115], a[32:35], v[80:83], v[112:115]
  buffer_load_dwordx4 v24, s[24:27], s63 offen offset:2048 lds
  v_mfma_f32_16x16x32_bf16 v[116:119], a[36:39], v[80:83], v[116:119]
  ds_read_b64 a[68:69], v16 offset:3136
  v_mfma_f32_16x16x32_bf16 v[120:123], a[40:43], v[80:83], v[120:123]
  ds_read_b64 a[70:71], v16 offset:3144
  v_mfma_f32_16x16x32_bf16 v[124:127], a[44:47], v[80:83], v[124:127]
  ds_read_b128 v[80:83], v14 offset:2112
  v_mfma_f32_16x16x32_bf16 v[108:111], a[32:35], v[76:79], v[108:111]
  ds_read_b64 a[72:73], v16 offset:2624
  s_waitcnt lgkmcnt(5)
  s_add_u32 m0, s61, 24576
  v_mfma_f32_16x16x32_bf16 v[112:115], a[36:39], v[76:79], v[112:115]
  ds_read_b64 a[74:75], v16 offset:2632
  s_add_u32 s63, s62, 704512
  buffer_load_dwordx4 v22, s[24:27], s63 offen lds
  v_mfma_f32_16x16x32_bf16 v[116:119], a[40:43], v[76:79], v[116:119]
  ds_read_b64 a[76:77], v16 offset:2112
  v_mfma_f32_16x16x32_bf16 v[120:123], a[44:47], v[76:79], v[120:123]
  ds_read_b64 a[78:79], v16 offset:2120
  v_mfma_f32_16x16x32_bf16 v[124:127], a[48:51], v[76:79], v[124:127]
  ds_read_b128 v[76:79], v14 offset:1600
  v_mfma_f32_16x16x32_bf16 v[104:107], a[32:35], v[72:75], v[104:107]
  buffer_load_dwordx4 v23, s[24:27], s63 offen offset:1024 lds
  v_mfma_f32_16x16x32_bf16 v[108:111], a[36:39], v[72:75], v[108:111]
  ds_read_b64 a[80:81], v16 offset:1600
  v_mfma_f32_16x16x32_bf16 v[112:115], a[40:43], v[72:75], v[112:115]
  ds_read_b64 a[82:83], v16 offset:1608
  v_mfma_f32_16x16x32_bf16 v[116:119], a[44:47], v[72:75], v[116:119]
  buffer_load_dwordx4 v24, s[24:27], s63 offen offset:2048 lds
  s_lshl_b32 s58, s3, 14
  v_mfma_f32_16x16x32_bf16 v[120:123], a[48:51], v[72:75], v[120:123]
  s_lshl_b32 s59, s6, 7
  s_add_u32 s58, s58, s59
  s_lshl_b32 s59, s81, 18
  v_mfma_f32_16x16x32_bf16 v[124:127], a[52:55], v[72:75], v[124:127]
  s_sub_u32 s77, s58, s59
  ds_read_b128 v[72:75], v14 offset:1088
  v_mfma_f32_16x16x32_bf16 v[100:103], a[32:35], v[68:71], v[100:103]
  ds_read_b64 a[84:85], v16 offset:1088
  s_add_u32 s58, s58, s59
  s_lshl_b32 s59, s81, 13
  v_mfma_f32_16x16x32_bf16 v[104:107], a[36:39], v[68:71], v[104:107]
  ds_read_b64 a[86:87], v16 offset:1096
  s_sub_u32 s79, s60, s59
  v_mfma_f32_16x16x32_bf16 v[108:111], a[40:43], v[68:71], v[108:111]
  ds_read_b64 a[88:89], v16 offset:576
  s_add_u32 s78, s60, s59
  v_mfma_f32_16x16x32_bf16 v[112:115], a[44:47], v[68:71], v[112:115]
  ds_read_b64 a[96:97], v16 offset:3584
  v_mfma_f32_16x16x32_bf16 v[116:119], a[48:51], v[68:71], v[116:119]
  s_add_u32 m0, s78, 0
  ds_read_b64 a[90:91], v16 offset:584
  s_add_u32 s59, s58, 0
  v_mfma_f32_16x16x32_bf16 v[120:123], a[52:55], v[68:71], v[120:123]
  buffer_load_dwordx4 v26, s[16:19], s59 offen offset:0  lds
  v_mfma_f32_16x16x32_bf16 v[124:127], a[56:59], v[68:71], v[124:127]
  ds_read_b128 v[68:71], v14 offset:576
  v_mfma_f32_16x16x32_bf16 v[96:99], a[32:35], v[64:67], v[96:99]
  ds_read_b64 a[98:99], v16 offset:3592
  ds_read_b64 a[92:93], v16 offset:64
  v_mfma_f32_16x16x32_bf16 v[100:103], a[36:39], v[64:67], v[100:103]
  ds_read_b64 a[94:95], v16 offset:72
  ds_read_b64 a[100:101], v16 offset:3072
  v_mfma_f32_16x16x32_bf16 v[104:107], a[40:43], v[64:67], v[104:107]
  buffer_load_dwordx4 v27, s[16:19], s59 offen offset:1024  lds
  v_mfma_f32_16x16x32_bf16 v[108:111], a[44:47], v[64:67], v[108:111]
  ds_read_b64 a[102:103], v16 offset:3080
  v_mfma_f32_16x16x32_bf16 v[112:115], a[48:51], v[64:67], v[112:115]
  ds_read_b64 a[104:105], v16 offset:2560
  v_mfma_f32_16x16x32_bf16 v[116:119], a[52:55], v[64:67], v[116:119]
  buffer_load_dwordx4 v28, s[16:19], s59 offen offset:2048  lds
  v_mfma_f32_16x16x32_bf16 v[120:123], a[56:59], v[64:67], v[120:123]
  ds_read_b64 a[106:107], v16 offset:2568
  v_mfma_f32_16x16x32_bf16 v[124:127], a[60:63], v[64:67], v[124:127]
  s_waitcnt lgkmcnt(4)
  ds_read_b128 v[64:67], v14 offset:64
  ds_read_b64 a[108:109], v16 offset:2048
  v_mfma_f32_16x16x32_bf16 v[124:127], a[64:67], v[92:95], v[124:127]
  ds_read_b128 v[92:95], v14 offset:3584
  v_mfma_f32_16x16x32_bf16 v[120:123], a[64:67], v[88:91], v[120:123]
  ds_read_b64 a[110:111], v16 offset:2056
  v_mfma_f32_16x16x32_bf16 v[124:127], a[68:71], v[88:91], v[124:127]
  ds_read_b128 v[88:91], v14 offset:3072
  buffer_load_dwordx4 v29, s[16:19], s59 offen offset:3072  lds
  v_mfma_f32_16x16x32_bf16 v[116:119], a[64:67], v[84:87], v[116:119]
  ds_read_b64 a[112:113], v16 offset:1536
  v_mfma_f32_16x16x32_bf16 v[120:123], a[68:71], v[84:87], v[120:123]
  ds_read_b64 a[114:115], v16 offset:1544
  s_add_u32 m0, s78, 4096
  v_mfma_f32_16x16x32_bf16 v[124:127], a[72:75], v[84:87], v[124:127]
  ds_read_b128 v[84:87], v14 offset:2560
  ds_read_b64 a[116:117], v16 offset:1024
  v_mfma_f32_16x16x32_bf16 v[112:115], a[64:67], v[80:83], v[112:115]
  ds_read_b64 a[118:119], v16 offset:1032
  s_add_u32 s59, s58, 131072
  v_mfma_f32_16x16x32_bf16 v[116:119], a[68:71], v[80:83], v[116:119]
  buffer_load_dwordx4 v26, s[16:19], s59 offen offset:0  lds
  v_mfma_f32_16x16x32_bf16 v[120:123], a[72:75], v[80:83], v[120:123]
  ds_read_b64 a[120:121], v16 offset:512
  v_mfma_f32_16x16x32_bf16 v[124:127], a[76:79], v[80:83], v[124:127]
  ds_read_b128 v[80:83], v14 offset:2048
  v_mfma_f32_16x16x32_bf16 v[108:111], a[64:67], v[76:79], v[108:111]
  buffer_load_dwordx4 v27, s[16:19], s59 offen offset:1024  lds
  v_mfma_f32_16x16x32_bf16 v[112:115], a[68:71], v[76:79], v[112:115]
  ds_read_b64 a[122:123], v16 offset:520
  ds_read_b64 a[124:125], v16 offset:0
  ds_read_b64 a[126:127], v16 offset:8
  v_mfma_f32_16x16x32_bf16 v[116:119], a[72:75], v[76:79], v[116:119]
  v_mfma_f32_16x16x32_bf16 v[120:123], a[76:79], v[76:79], v[120:123]
  v_mfma_f32_16x16x32_bf16 v[124:127], a[80:83], v[76:79], v[124:127]
  ds_read_b128 v[76:79], v14 offset:1536
  v_mfma_f32_16x16x32_bf16 v[104:107], a[64:67], v[72:75], v[104:107]
  buffer_load_dwordx4 v28, s[16:19], s59 offen offset:2048  lds
  v_mfma_f32_16x16x32_bf16 v[108:111], a[68:71], v[72:75], v[108:111]
  v_lshlrev_b32 v128, 16, v32
  v_mfma_f32_16x16x32_bf16 v[112:115], a[72:75], v[72:75], v[112:115]
  v_and_b32 v129, s73, v32
  v_mfma_f32_16x16x32_bf16 v[116:119], a[76:79], v[72:75], v[116:119]
  buffer_load_dwordx4 v29, s[16:19], s59 offen offset:3072  lds
  v_mfma_f32_16x16x32_bf16 v[120:123], a[80:83], v[72:75], v[120:123]
  v_lshlrev_b32 v130, 16, v33
  v_mfma_f32_16x16x32_bf16 v[124:127], a[84:87], v[72:75], v[124:127]
  s_add_u32 m0, s79, 8192
  ds_read_b128 v[72:75], v14 offset:1024
  v_mfma_f32_16x16x32_bf16 v[100:103], a[64:67], v[68:71], v[100:103]
  s_add_u32 s59, s77, 262144
  v_and_b32 v131, s73, v33
  v_mfma_f32_16x16x32_bf16 v[104:107], a[68:71], v[68:71], v[104:107]
  buffer_load_dwordx4 v26, s[16:19], s59 offen offset:0  lds
  v_mfma_f32_16x16x32_bf16 v[108:111], a[72:75], v[68:71], v[108:111]
  v_lshlrev_b32 v132, 16, v34
  v_mfma_f32_16x16x32_bf16 v[112:115], a[76:79], v[68:71], v[112:115]
  v_and_b32 v133, s73, v34
  v_mfma_f32_16x16x32_bf16 v[116:119], a[80:83], v[68:71], v[116:119]
  v_mfma_f32_16x16x32_bf16 v[120:123], a[84:87], v[68:71], v[120:123]
  buffer_load_dwordx4 v27, s[16:19], s59 offen offset:1024  lds
  v_mfma_f32_16x16x32_bf16 v[124:127], a[88:91], v[68:71], v[124:127]
  s_waitcnt lgkmcnt(14)
  ds_read_b128 v[68:71], v14 offset:512
  v_lshlrev_b32 v134, 16, v35
  v_mfma_f32_16x16x32_bf16 v[96:99], a[64:67], v[64:67], v[96:99]
  s_waitcnt vmcnt(19)
  ds_read_b64_tr_b16 a[236:237], v19 offset:0
  v_and_b32 v135, s73, v35
  v_mfma_f32_16x16x32_bf16 v[100:103], a[68:71], v[64:67], v[100:103]
  ds_read_b64_tr_b16 a[238:239], v19 offset:1536
  v_mfma_f32_16x16x32_bf16 v[104:107], a[72:75], v[64:67], v[104:107]
  buffer_load_dwordx4 v28, s[16:19], s59 offen offset:2048  lds
  v_mfma_f32_16x16x32_bf16 v[108:111], a[76:79], v[64:67], v[108:111]
  ds_read_b64_tr_b16 a[240:241], v19 offset:32
  v_lshlrev_b32 v136, 16, v36
  v_mfma_f32_16x16x32_bf16 v[112:115], a[80:83], v[64:67], v[112:115]
  v_and_b32 v137, s73, v36
  v_mfma_f32_16x16x32_bf16 v[116:119], a[84:87], v[64:67], v[116:119]
  ds_read_b64_tr_b16 a[242:243], v19 offset:1568
  v_lshlrev_b32 v138, 16, v37
  v_mfma_f32_16x16x32_bf16 v[120:123], a[88:91], v[64:67], v[120:123]
  v_mfma_f32_16x16x32_bf16 v[124:127], a[92:95], v[64:67], v[124:127]
  s_waitcnt lgkmcnt(7)
  ds_read_b128 v[64:67], v14 offset:0
  v_and_b32 v139, s73, v37
  v_mfma_f32_16x16x32_bf16 v[124:127], a[96:99], v[92:95], v[124:127]
  buffer_load_dwordx4 v29, s[16:19], s59 offen offset:3072  lds
  v_mfma_f32_16x16x32_bf16 v[120:123], a[96:99], v[88:91], v[120:123]
  ds_read_b64_tr_b16 a[244:245], v19 offset:64
  s_add_u32 m0, s79, 12288
  v_lshlrev_b32 v140, 16, v38
  v_mfma_f32_16x16x32_bf16 v[124:127], a[100:103], v[88:91], v[124:127]
  ds_read_b64_tr_b16 a[246:247], v19 offset:1600
  s_add_u32 s59, s77, 393216
  v_mfma_f32_16x16x32_bf16 v[116:119], a[96:99], v[84:87], v[116:119]
  buffer_load_dwordx4 v26, s[16:19], s59 offen offset:0  lds
  v_mfma_f32_16x16x32_bf16 v[120:123], a[100:103], v[84:87], v[120:123]
  s_waitcnt vmcnt(19)
  ds_read_b64_tr_b16 a[248:249], v19 offset:3072
  v_and_b32 v141, s73, v38
  v_mfma_f32_16x16x32_bf16 v[124:127], a[104:107], v[84:87], v[124:127]
  ds_read_b64_tr_b16 a[250:251], v19 offset:4608
  v_lshlrev_b32 v142, 16, v39
  v_mfma_f32_16x16x32_bf16 v[112:115], a[96:99], v[80:83], v[112:115]
  ds_read_b64_tr_b16 a[252:253], v19 offset:3104
  v_and_b32 v143, s73, v39
  v_mfma_f32_16x16x32_bf16 v[116:119], a[100:103], v[80:83], v[116:119]
  buffer_load_dwordx4 v27, s[16:19], s59 offen offset:1024  lds
  v_mfma_f32_16x16x32_bf16 v[120:123], a[104:107], v[80:83], v[120:123]
Lpage2:
  s_cbranch_execz Lback2
  ds_read_b64_tr_b16 a[254:255], v19 offset:4640
  v_add_u32 v12, s61, v3
  v_mfma_f32_16x16x32_bf16 v[124:127], a[108:111], v[80:83], v[124:127]
  s_waitcnt lgkmcnt(13)
  ds_read_b64_tr_b16 v[144:145], v19 offset:3136
  s_xor_b32 s66, s3, 1
  v_mfma_f32_16x16x32_bf16 v[108:111], a[96:99], v[76:79], v[108:111]
  s_mul_i32 s66, s66, 6144
  v_mfma_f32_16x16x32_bf16 v[112:115], a[100:103], v[76:79], v[112:115]
  buffer_load_dwordx4 v28, s[16:19], s59 offen offset:2048  lds
  s_add_u32 s66, s66, 110592
  v_mfma_f32_16x16x32_bf16 v[116:119], a[104:107], v[76:79], v[116:119]
  s_movk_i32 s0, 24576
  buffer_load_dword v56, v5, s[8:11], s0 offen sc1
  v_mfma_f32_16x16x32_bf16 v[120:123], a[108:111], v[76:79], v[120:123]
  ds_read_b64_tr_b16 v[146:147], v19 offset:4672
  v_add_u32 v15, s66, v3
  v_mfma_f32_16x16x32_bf16 v[124:127], a[112:115], v[76:79], v[124:127]
  s_waitcnt lgkmcnt(14)
  s_waitcnt vmcnt(19)
  ds_read_b64_tr_b16 v[148:149], v19 offset:27648
  v_mfma_f32_16x16x32_bf16 v[104:107], a[96:99], v[72:75], v[104:107]
  buffer_load_dwordx4 v29, s[16:19], s59 offen offset:3072  lds
  v_mfma_f32_16x16x32_bf16 v[108:111], a[100:103], v[72:75], v[108:111]
  ds_read_b64_tr_b16 v[150:151], v19 offset:29184
  v_and_b32 v18, 1, v21
  v_mfma_f32_16x16x32_bf16 v[112:115], a[104:107], v[72:75], v[112:115]
  ds_read_b64_tr_b16 v[152:153], v19 offset:27680
  v_lshlrev_b32 v18, 9, v18
  v_mfma_f32_16x16x32_bf16 v[116:119], a[108:111], v[72:75], v[116:119]
  ds_read_b64_tr_b16 v[154:155], v19 offset:29216
  v_lshl_add_u32 v18, v20, 5, v18
  v_mfma_f32_16x16x32_bf16 v[120:123], a[112:115], v[72:75], v[120:123]
  s_mul_i32 s58, s5, 176128
  s_add_u32 s58, s58, 9437696
  s_mul_i32 s59, s6, 688
  v_min_u32 v6, 687, v0
  v_add_u32 v6, s59, v6
  v_and_b32 v4, 0xffe0, v6
  v_add_lshl_u32 v6, v6, v4, 4
  buffer_store_dwordx4 v[8:11], v6, s[8:11], s58 offen sc1
  s_add_u32 s59, s59, 256
  v_mfma_f32_16x16x32_bf16 v[124:127], a[116:119], v[72:75], v[124:127]
  s_waitcnt lgkmcnt(14)
  ds_read_b64_tr_b16 v[156:157], v19 offset:27712
  v_and_b32 v31, 2, v21
  v_mfma_f32_16x16x32_bf16 v[100:103], a[96:99], v[68:71], v[100:103]
  ds_read_b64_tr_b16 v[158:159], v19 offset:29248
  v_lshl_add_u32 v18, v31, 3, v18
  v_mfma_f32_16x16x32_bf16 v[104:107], a[100:103], v[68:71], v[104:107]
  s_lshl_b32 s66, s4, 1
  s_add_u32 s66, s66, s64
  s_mul_i32 s66, s66, 4224
  v_mfma_f32_16x16x32_bf16 v[108:111], a[104:107], v[68:71], v[108:111]
  v_min_u32 v6, 431, v0
  v_add_u32 v6, s59, v6
  v_and_b32 v4, 0xffe0, v6
  v_add_lshl_u32 v6, v6, v4, 4
  buffer_store_dwordx4 v[8:11], v6, s[8:11], s58 offen sc1
  s_add_u32 s59, s59, 256
  v_mfma_f32_16x16x32_bf16 v[112:115], a[108:111], v[68:71], v[112:115]
  s_lshl_b32 s67, s65, 11
  s_waitcnt vmcnt(19)
  ds_read_b64_tr_b16 v[160:161], v19 offset:24576
  v_mfma_f32_16x16x32_bf16 v[116:119], a[112:115], v[68:71], v[116:119]
  s_add_u32 s66, s66, s67
  s_add_u32 s66, s66, 6291456
  ds_read_b64_tr_b16 v[162:163], v19 offset:26112
  v_mfma_f32_16x16x32_bf16 v[120:123], a[116:119], v[68:71], v[120:123]
  v_mfma_f32_16x16x32_bf16 v[124:127], a[120:123], v[68:71], v[124:127]
  s_waitcnt lgkmcnt(14)
  v_min_u32 v6, 175, v0
  v_add_u32 v6, s59, v6
  v_and_b32 v4, 0xffe0, v6
  v_add_lshl_u32 v6, v6, v4, 4
  buffer_store_dwordx4 v[8:11], v6, s[8:11], s58 offen sc1
  s_add_u32 s59, s59, 256
  v_mfma_f32_16x16x32_bf16 v[96:99], a[96:99], v[64:67], v[96:99]
  ds_read_b64_tr_b16 v[164:165], v19 offset:24608
  v_mfma_f32_16x16x32_bf16 v[100:103], a[100:103], v[64:67], v[100:103]
  ds_read_b64_tr_b16 v[166:167], v19 offset:26144
  v_mfma_f32_16x16x32_bf16 v[104:107], a[104:107], v[64:67], v[104:107]
  ds_read_b64_tr_b16 v[168:169], v19 offset:24640
  v_mfma_f32_16x16x32_bf16 v[108:111], a[108:111], v[64:67], v[108:111]
  v_mfma_f32_16x16x32_bf16 v[112:115], a[112:115], v[64:67], v[112:115]
  ds_read_b64_tr_b16 v[170:171], v19 offset:26176
  v_mfma_f32_16x16x32_bf16 v[116:119], a[116:119], v[64:67], v[116:119]
  v_mfma_f32_16x16x32_bf16 v[120:123], a[120:123], v[64:67], v[120:123]
  v_mfma_f32_16x16x32_bf16 v[124:127], a[124:127], v[64:67], v[124:127]
  s_waitcnt lgkmcnt(0)
  s_cmp_eq_u32 s65, 1
  s_cbranch_scc1 Lch11
  s_nop 5
  ds_write_b128 v12, v[112:115] offset:0
  ds_write_b128 v12, v[116:119] offset:1024
  ds_write_b128 v12, v[120:123] offset:2048
  ds_write_b128 v12, v[124:127] offset:3072
  v_pk_add_f32 v[128:129], v[128:129], v[96:97]
  v_pk_add_f32 v[130:131], v[130:131], v[98:99]
  v_pk_add_f32 v[132:133], v[132:133], v[100:101]
  v_pk_add_f32 v[134:135], v[134:135], v[102:103]
  v_pk_add_f32 v[136:137], v[136:137], v[104:105]
  v_pk_add_f32 v[138:139], v[138:139], v[106:107]
  v_pk_add_f32 v[140:141], v[140:141], v[108:109]
  v_pk_add_f32 v[142:143], v[142:143], v[110:111]
  s_branch Lcj12
Lch11:
  s_nop 5
  ds_write_b128 v12, v[96:99] offset:0
  ds_write_b128 v12, v[100:103] offset:1024
  ds_write_b128 v12, v[104:107] offset:2048
  ds_write_b128 v12, v[108:111] offset:3072
  v_pk_add_f32 v[128:129], v[128:129], v[112:113]
  v_pk_add_f32 v[130:131], v[130:131], v[114:115]
  v_pk_add_f32 v[132:133], v[132:133], v[116:117]
  v_pk_add_f32 v[134:135], v[134:135], v[118:119]
  v_pk_add_f32 v[136:137], v[136:137], v[120:121]
  v_pk_add_f32 v[138:139], v[138:139], v[122:123]
  v_pk_add_f32 v[140:141], v[140:141], v[124:125]
  v_pk_add_f32 v[142:143], v[142:143], v[126:127]
Lcj12:
  s_waitcnt lgkmcnt(0)
  s_barrier
  ds_read_b128 v[32:35], v15 offset:0
  ds_read_b128 v[36:39], v15 offset:1024
  ds_read_b128 v[40:43], v15 offset:2048
  ds_read_b128 v[44:47], v15 offset:3072
  s_waitcnt lgkmcnt(3)
  v_pk_add_f32 v[128:129], v[128:129], v[32:33]
  v_pk_add_f32 v[130:131], v[130:131], v[34:35]
  v_cvt_pk_bf16_f32 v48, v128, v129
  v_cvt_pk_bf16_f32 v49, v130, v131
  s_waitcnt lgkmcnt(2)
  v_pk_add_f32 v[132:133], v[132:133], v[36:37]
  v_pk_add_f32 v[134:135], v[134:135], v[38:39]
  v_cvt_pk_bf16_f32 v50, v132, v133
  v_cvt_pk_bf16_f32 v51, v134, v135
  s_nop 0
  v_permlane16_swap_b32 v48, v50
  v_permlane16_swap_b32 v49, v51
  s_nop 0
  buffer_store_dwordx4 v[48:51], v18, s[8:11], s66 offen offset:0 sc1
  s_waitcnt lgkmcnt(1)
  v_pk_add_f32 v[136:137], v[136:137], v[40:41]
  v_pk_add_f32 v[138:139], v[138:139], v[42:43]
  v_cvt_pk_bf16_f32 v52, v136, v137
  v_cvt_pk_bf16_f32 v53, v138, v139
  s_waitcnt lgkmcnt(0)
  v_pk_add_f32 v[140:141], v[140:141], v[44:45]
  v_pk_add_f32 v[142:143], v[142:143], v[46:47]
  v_cvt_pk_bf16_f32 v54, v140, v141
  v_cvt_pk_bf16_f32 v55, v142, v143
  s_nop 0
  v_permlane16_swap_b32 v52, v54
  v_permlane16_swap_b32 v53, v55
  s_nop 0
  buffer_store_dwordx4 v[52:55], v18, s[8:11], s66 offen offset:1024 sc1
  s_waitcnt vmcnt(6)
  v_cmp_ne_u32 vcc, s7, v56
  s_cbranch_vccnz Lretry9
Lcont10:
  v_bfe_u32 v30, v1, 2, 2
  v_and_b32 v31, 3, v1
  v_lshl_add_u32 v12, v21, 2, v30
  v_lshlrev_b32 v12, 7, v12
  v_lshl_add_u32 v12, v31, 3, v12
  v_bfe_u32 v30, v1, 3, 2
  v_lshl_add_u32 v12, v30, 5, v12
  v_xor_b32 v13, 32, v12
  v_xor_b32 v14, 64, v12
  v_xor_b32 v15, 96, v12
  s_lshl_b32 s67, s3, 5
  v_xor_b32 v18, s67, v12
  v_add_u32 v16, 65536, v18
  v_mov_b32 v4, v26
  s_waitcnt vmcnt(5)
  s_barrier
  ds_read_b64_tr_b16 v[80:81], v18 offset:0
  s_add_u32 m0, s61, 27648
  s_add_u32 s63, s62, 792576
  buffer_load_dwordx4 v22, s[24:27], s63 offen lds
  ds_read_b64_tr_b16 v[82:83], v18 offset:2048
  ds_read_b64_tr_b16 v[84:85], v18 offset:4096
  ds_read_b64_tr_b16 v[86:87], v18 offset:6144
  ds_read_b64_tr_b16 v[88:89], v18 offset:8192
  ds_read_b64_tr_b16 v[90:91], v18 offset:10240
  ds_read_b64_tr_b16 v[92:93], v18 offset:12288
  ds_read_b64_tr_b16 v[94:95], v18 offset:14336
  ds_read_b64_tr_b16 v[96:97], v18 offset:16384
  ds_read_b64_tr_b16 v[98:99], v18 offset:18432
  ds_read_b64_tr_b16 v[100:101], v18 offset:20480
  ds_read_b64_tr_b16 v[102:103], v18 offset:22528
  ds_read_b64_tr_b16 v[104:105], v18 offset:24576
  ds_read_b64_tr_b16 v[106:107], v18 offset:26624
  ds_read_b64_tr_b16 v[108:109], v18 offset:28672
  buffer_load_dwordx4 v23, s[24:27], s63 offen offset:1024 lds
  ds_read_b64_tr_b16 v[110:111], v18 offset:30720
  v_lshrrev_b32 v30, 3, v1
  v_mul_u32_u24 v30, 4224, v30
  v_and_b32 v31, 7, v1
  v_lshlrev_b32 v26, 1, v21
  v_xor_b32 v31, v31, v26
  v_lshl_add_u32 v26, v31, 4, v30
  v_add_u32 v27, 32768, v26
  v_add_u32 v28, 268288, v26
  v_add_u32 v29, 301056, v26
  v_mov_b32 v72, 0x3f803f80
  v_mov_b32 v73, 0x3f803f80
  v_mov_b32 v74, 0x3f803f80
  v_mov_b32 v75, 0x3f803f80
  s_lshl_b32 s64, s3, 12
  buffer_load_dwordx4 v24, s[24:27], s63 offen offset:2048 lds
  s_add_u32 s64, s64, 65536
  s_mul_i32 s65, s3, 540672
  s_lshl_b32 s66, s5, 7
  s_add_u32 s65, s65, s66
  s_add_u32 s65, s65, 6291456
  v_add_u32 v17, s64, v3
  s_mov_b32 s74, 0xc0135761
  s_mov_b32 s75, 0xbdd2d3e8
  s_mov_b32 s34, 0x200000
  s_mov_b32 s35, 0x20000
  s_lshl_b32 s68, s3, 10
  s_lshl_b32 s69, s3, 13
  s_lshl_b32 s67, s6, 7
  s_add_u32 s69, s69, s67
  s_lshl_b32 s67, s81, 17
  s_add_u32 m0, s61, 24576
  s_add_u32 s63, s62, 880640
  buffer_load_dwordx4 v22, s[24:27], s63 offen lds
  s_sub_u32 s77, s69, s67
  s_add_u32 s69, s69, s67
  s_lshl_b32 s67, s81, 14
  s_sub_u32 s79, s68, s67
  s_add_u32 s78, s68, s67
  ds_read_b64_tr_b16 v[112:113], v18 offset:32768
  ds_read_b64_tr_b16 v[114:115], v18 offset:34816
  ds_read_b64_tr_b16 v[116:117], v18 offset:36864
  ds_read_b64_tr_b16 v[118:119], v18 offset:38912
  ds_read_b64_tr_b16 v[120:121], v18 offset:40960
  ds_read_b64_tr_b16 v[122:123], v18 offset:43008
  ds_read_b64_tr_b16 v[124:125], v18 offset:45056
  ds_read_b64_tr_b16 v[126:127], v18 offset:47104
  ds_read_b64_tr_b16 v[128:129], v18 offset:49152
  ds_read_b64_tr_b16 v[130:131], v18 offset:51200
  buffer_load_dwordx4 v23, s[24:27], s63 offen offset:1024 lds
  ds_read_b64_tr_b16 v[132:133], v18 offset:53248
  ds_read_b64_tr_b16 v[134:135], v18 offset:55296
  ds_read_b64_tr_b16 v[136:137], v18 offset:57344
  ds_read_b64_tr_b16 v[138:139], v18 offset:59392
  ds_read_b64_tr_b16 v[140:141], v18 offset:61440
  ds_read_b64_tr_b16 v[142:143], v18 offset:63488
  s_waitcnt lgkmcnt(14)
  v_mfma_f32_16x16x32_bf16 v[64:67], v[80:83], v[72:75], 0
  s_waitcnt lgkmcnt(14)
  ds_read_b64_tr_b16 a[0:1], v12 offset:0
  v_mfma_f32_16x16x32_bf16 v[64:67], v[84:87], v[72:75], v[64:67]
  s_waitcnt lgkmcnt(14)
  ds_read_b64_tr_b16 a[2:3], v12 offset:2048
  v_mfma_f32_16x16x32_bf16 v[64:67], v[88:91], v[72:75], v[64:67]
  s_waitcnt lgkmcnt(14)
  buffer_load_dwordx4 v24, s[24:27], s63 offen offset:2048 lds
  ds_read_b64_tr_b16 a[4:5], v13 offset:0
  v_mfma_f32_16x16x32_bf16 v[64:67], v[92:95], v[72:75], v[64:67]
  s_waitcnt lgkmcnt(14)
  ds_read_b64_tr_b16 a[6:7], v13 offset:2048
  ds_read_b64_tr_b16 a[8:9], v14 offset:0
  v_mfma_f32_16x16x32_bf16 v[64:67], v[96:99], v[72:75], v[64:67]
  s_waitcnt lgkmcnt(14)
  ds_read_b64_tr_b16 a[10:11], v14 offset:2048
  ds_read_b64_tr_b16 a[12:13], v15 offset:0
  v_mfma_f32_16x16x32_bf16 v[64:67], v[100:103], v[72:75], v[64:67]
  s_waitcnt lgkmcnt(14)
  ds_read_b64_tr_b16 a[14:15], v15 offset:2048
  ds_read_b64_tr_b16 a[16:17], v12 offset:4096
  ds_read_b64_tr_b16 a[18:19], v12 offset:6144
  v_mfma_f32_16x16x32_bf16 v[64:67], v[104:107], v[72:75], v[64:67]
  s_waitcnt lgkmcnt(14)
  ds_read_b64_tr_b16 a[20:21], v13 offset:4096
  ds_read_b64_tr_b16 a[22:23], v13 offset:6144
  ds_read_b64_tr_b16 a[24:25], v14 offset:4096
  ds_read_b64_tr_b16 a[26:27], v14 offset:6144
  ds_read_b64_tr_b16 a[28:29], v15 offset:4096
  v_mfma_f32_16x16x32_bf16 v[64:67], v[108:111], v[72:75], v[64:67]
  s_waitcnt lgkmcnt(14)
  ds_read_b64_tr_b16 a[30:31], v15 offset:6144
  ds_read_b64_tr_b16 a[32:33], v12 offset:8192
  ds_read_b64_tr_b16 a[34:35], v12 offset:10240
  ds_read_b64_tr_b16 a[36:37], v13 offset:8192
  ds_read_b64_tr_b16 a[38:39], v13 offset:10240
  v_mfma_f32_16x16x32_bf16 v[64:67], v[112:115], v[72:75], v[64:67]
  s_waitcnt lgkmcnt(14)
  ds_read_b64_tr_b16 a[40:41], v14 offset:8192
  ds_read_b64_tr_b16 a[42:43], v14 offset:10240
  ds_read_b64_tr_b16 a[44:45], v15 offset:8192
  ds_read_b64_tr_b16 a[46:47], v15 offset:10240
  ds_read_b64_tr_b16 a[48:49], v12 offset:12288
  v_mfma_f32_16x16x32_bf16 v[64:67], v[116:119], v[72:75], v[64:67]
  s_waitcnt lgkmcnt(14)
  ds_read_b64_tr_b16 a[50:51], v12 offset:14336
  ds_read_b64_tr_b16 a[52:53], v13 offset:12288
  ds_read_b64_tr_b16 a[54:55], v13 offset:14336
  ds_read_b64_tr_b16 a[56:57], v14 offset:12288
  ds_read_b64_tr_b16 a[58:59], v14 offset:14336
  v_mfma_f32_16x16x32_bf16 v[64:67], v[120:123], v[72:75], v[64:67]
  s_waitcnt lgkmcnt(14)
  ds_read_b64_tr_b16 a[60:61], v15 offset:12288
  ds_read_b64_tr_b16 a[62:63], v15 offset:14336
  ds_read_b64_tr_b16 a[64:65], v12 offset:16384
  ds_read_b64_tr_b16 a[66:67], v12 offset:18432
  ds_read_b64_tr_b16 a[68:69], v13 offset:16384
  v_mfma_f32_16x16x32_bf16 v[64:67], v[124:127], v[72:75], v[64:67]
  s_waitcnt lgkmcnt(14)
  ds_read_b64_tr_b16 a[70:71], v13 offset:18432
  ds_read_b64_tr_b16 a[72:73], v14 offset:16384
  ds_read_b64_tr_b16 a[74:75], v14 offset:18432
  ds_read_b64_tr_b16 a[76:77], v15 offset:16384
  ds_read_b64_tr_b16 a[78:79], v15 offset:18432
  v_mfma_f32_16x16x32_bf16 v[64:67], v[128:131], v[72:75], v[64:67]
  s_waitcnt lgkmcnt(14)
  ds_read_b64_tr_b16 a[80:81], v12 offset:20480
  ds_read_b64_tr_b16 a[82:83], v12 offset:22528
  ds_read_b64_tr_b16 a[84:85], v13 offset:20480
  ds_read_b64_tr_b16 a[86:87], v13 offset:22528
  ds_read_b64_tr_b16 a[88:89], v14 offset:20480
  v_mfma_f32_16x16x32_bf16 v[64:67], v[132:135], v[72:75], v[64:67]
  s_waitcnt lgkmcnt(14)
  ds_read_b64_tr_b16 a[90:91], v14 offset:22528
  ds_read_b64_tr_b16 a[92:93], v15 offset:20480
  ds_read_b64_tr_b16 a[94:95], v15 offset:22528
  ds_read_b64_tr_b16 a[96:97], v12 offset:24576
  ds_read_b64_tr_b16 a[98:99], v12 offset:26624
  v_mfma_f32_16x16x32_bf16 v[64:67], v[136:139], v[72:75], v[64:67]
  s_waitcnt lgkmcnt(14)
  ds_read_b64_tr_b16 a[100:101], v13 offset:24576
  ds_read_b64_tr_b16 a[102:103], v13 offset:26624
  ds_read_b64_tr_b16 a[104:105], v14 offset:24576
  ds_read_b64_tr_b16 a[106:107], v14 offset:26624
  ds_read_b64_tr_b16 a[108:109], v15 offset:24576
  v_mfma_f32_16x16x32_bf16 v[64:67], v[140:143], v[72:75], v[64:67]
  ds_read_b64_tr_b16 a[110:111], v15 offset:26624
  ds_read_b64_tr_b16 a[112:113], v12 offset:28672
  ds_read_b64_tr_b16 a[114:115], v12 offset:30720
  ds_read_b64_tr_b16 a[116:117], v13 offset:28672
  ds_read_b64_tr_b16 a[118:119], v13 offset:30720
  ds_read_b64_tr_b16 a[120:121], v14 offset:28672
  ds_read_b64_tr_b16 a[122:123], v14 offset:30720
  ds_read_b64_tr_b16 a[124:125], v15 offset:28672
  ds_read_b64_tr_b16 a[126:127], v15 offset:30720
  ds_read_b64_tr_b16 a[128:129], v12 offset:32768
  ds_read_b64_tr_b16 a[130:131], v12 offset:34816
  ds_read_b64_tr_b16 a[132:133], v13 offset:32768
  ds_read_b64_tr_b16 a[134:135], v13 offset:34816
  ds_read_b64_tr_b16 a[136:137], v14 offset:32768
  ds_read_b64_tr_b16 a[138:139], v14 offset:34816
  ds_read_b64_tr_b16 a[140:141], v15 offset:32768
  ds_read_b64_tr_b16 a[142:143], v15 offset:34816
  ds_read_b64_tr_b16 a[144:145], v12 offset:36864
  ds_read_b64_tr_b16 a[146:147], v12 offset:38912
  ds_read_b64_tr_b16 a[148:149], v13 offset:36864
  ds_read_b64_tr_b16 a[150:151], v13 offset:38912
  ds_read_b64_tr_b16 a[152:153], v14 offset:36864
  ds_read_b64_tr_b16 a[154:155], v14 offset:38912
  ds_read_b64_tr_b16 a[156:157], v15 offset:36864
  ds_read_b64_tr_b16 a[158:159], v15 offset:38912
  s_waitcnt vmcnt(6)
  s_add_u32 m0, s64, 0
  s_add_u32 s66, s65, 0
  buffer_load_dwordx4 v26, s[8:11], s66 offen offset:0 sc1 lds
  ds_read_b64_tr_b16 a[160:161], v12 offset:40960
  ds_read_b64_tr_b16 a[162:163], v12 offset:43008
  buffer_load_dwordx4 v27, s[8:11], s66 offen offset:1024 sc1 lds
  ds_read_b64_tr_b16 a[164:165], v13 offset:40960
  ds_read_b64_tr_b16 a[166:167], v13 offset:43008
  buffer_load_dwordx4 v28, s[8:11], s66 offen offset:2048 sc1 lds
  buffer_load_dwordx4 v29, s[8:11], s66 offen offset:3072 sc1 lds
  ds_read_b64_tr_b16 a[168:169], v14 offset:40960
  ds_read_b64_tr_b16 a[170:171], v14 offset:43008
  s_add_u32 m0, s64, 16384
  s_add_u32 s66, s65, 67584
  buffer_load_dwordx4 v26, s[8:11], s66 offen offset:0 sc1 lds
  buffer_load_dwordx4 v27, s[8:11], s66 offen offset:1024 sc1 lds
  ds_read_b64_tr_b16 a[172:173], v15 offset:40960
  ds_read_b64_tr_b16 a[174:175], v15 offset:43008
  buffer_load_dwordx4 v28, s[8:11], s66 offen offset:2048 sc1 lds
  buffer_load_dwordx4 v29, s[8:11], s66 offen offset:3072 sc1 lds
  v_lshlrev_b32 v30, 2, v21
  v_sub_u32 v30, v20, v30
  s_add_u32 s67, s68, 131072
  v_add_u32 v31, s67, v3
  v_cmp_eq_u32 vcc, 0, v30
  s_nop 1
  v_cndmask_b32 v76, 0, 1.0, vcc
  v_cmp_eq_u32 vcc, 1, v30
  s_nop 1
  v_cndmask_b32 v77, 0, 1.0, vcc
  v_cmp_eq_u32 vcc, 2, v30
  s_nop 1
  v_cndmask_b32 v78, 0, 1.0, vcc
  v_cmp_eq_u32 vcc, 3, v30
  s_nop 1
  v_cndmask_b32 v79, 0, 1.0, vcc
  ds_write_b128 v31, v[64:67]
  v_add_u32 v31, 131072, v3
  s_lshr_b32 s12, s6, 1
  s_lshr_b32 s13, s12, 1
  s_add_u32 s13, s13, 1
  s_sub_u32 s14, 0, s13
  s_bitcmp1_b32 s12, 0
  s_cselect_b32 s13, s14, s13
  s_lshl_b32 s14, s5, 6
  s_lshl_b32 s12, s3, 4
  s_add_u32 s14, s14, s12
  s_add_u32 s13, s13, s14
  v_add_u32 v30, s13, v20
  v_bfe_u32 v128, v30, 6, 2
  v_mul_u32_u24 v128, 1056768, v128
  v_bfe_u32 v130, v30, 8, 3
  v_lshl_add_u32 v128, v130, 11, v128
  v_and_b32 v130, 63, v30
  v_lshl_add_u32 v128, v130, 4, v128
  v_lshrrev_b32 v130, 1, v21
  v_mul_u32_u24 v130, 14464, v130
  v_lshl_add_u32 v2, v21, 10, v130
  v_add_u32 v128, v128, v2
  v_bfrev_b32 v130, 1
  v_cmp_gt_u32 vcc, 2048, v30
  s_lshl_b32 s12, s6, 11
  v_add_u32 v129, s12, v16
  v_cndmask_b32 v128, v130, v128, vcc
  s_mul_i32 s71, s6, 66048
  s_add_u32 s12, s71, 1048576
  s_add_u32 s13, s12, 33024
  s_waitcnt vmcnt(4)
  ds_read_b64 v[112:113], v17 offset:0
  ds_read_b64 v[114:115], v17 offset:1024
  ds_read_b64 v[116:117], v17 offset:2048
  ds_read_b64 v[118:119], v17 offset:3072
  s_waitcnt lgkmcnt(0)
  v_max3_u32 v30, v112, v114, v116
  v_max_u32 v30, v30, v118
  v_cmp_eq_u32 vcc, -1, v30
  s_cbranch_vccnz Lretry13
Lcont14:
  s_barrier
  ds_read_b64_tr_b16 v[80:81], v16 offset:0
  ds_read_b64_tr_b16 v[82:83], v16 offset:2048
  ds_read_b64_tr_b16 v[84:85], v16 offset:4096
  ds_read_b64_tr_b16 v[86:87], v16 offset:6144
  ds_read_b64_tr_b16 v[88:89], v16 offset:8192
  ds_read_b64_tr_b16 v[90:91], v16 offset:10240
  ds_read_b64_tr_b16 v[92:93], v16 offset:12288
  ds_read_b64_tr_b16 v[94:95], v16 offset:14336
  s_waitcnt lgkmcnt(6)
  v_mfma_f32_16x16x32_bf16 v[68:71], v[80:83], v[80:83], 0
  s_add_u32 m0, s64, 32768
  s_add_u32 s66, s65, 135168
  v_mfma_f32_16x16x32_bf16 v[64:67], v[72:75], v[80:83], 0
  buffer_load_dwordx4 v26, s[8:11], s66 offen offset:0 sc1 lds
  v_mfma_f32_16x16x32_bf16 v[32:35], a[0:3], v[80:83], 0
  buffer_load_dwordx4 v27, s[8:11], s66 offen offset:1024 sc1 lds
  v_mfma_f32_16x16x32_bf16 v[36:39], a[4:7], v[80:83], 0
  buffer_load_dwordx4 v28, s[8:11], s66 offen offset:2048 sc1 lds
  v_mfma_f32_16x16x32_bf16 v[40:43], a[8:11], v[80:83], 0
  v_mfma_f32_16x16x32_bf16 v[44:47], a[12:15], v[80:83], 0
  s_waitcnt lgkmcnt(4)
  buffer_load_dwordx4 v29, s[8:11], s66 offen offset:3072 sc1 lds
  v_mfma_f32_16x16x32_bf16 v[68:71], v[84:87], v[84:87], v[68:71]
  s_add_u32 m0, s64, 49152
  s_waitcnt vmcnt(4)
  ds_read_b64 v[112:113], v17 offset:16384
  v_mfma_f32_16x16x32_bf16 v[64:67], v[72:75], v[84:87], v[64:67]
  s_add_u32 s66, s65, 202752
  buffer_load_dwordx4 v26, s[8:11], s66 offen offset:0 sc1 lds
  v_mfma_f32_16x16x32_bf16 v[32:35], a[16:19], v[84:87], v[32:35]
  buffer_load_dwordx4 v27, s[8:11], s66 offen offset:1024 sc1 lds
  v_mfma_f32_16x16x32_bf16 v[36:39], a[20:23], v[84:87], v[36:39]
  ds_read_b64 v[114:115], v17 offset:17408
  ds_read_b64 v[116:117], v17 offset:18432
  ds_read_b64 v[118:119], v17 offset:19456
  v_mfma_f32_16x16x32_bf16 v[40:43], a[24:27], v[84:87], v[40:43]
  buffer_load_dwordx4 v28, s[8:11], s66 offen offset:2048 sc1 lds
  v_mfma_f32_16x16x32_bf16 v[44:47], a[28:31], v[84:87], v[44:47]
  s_waitcnt lgkmcnt(6)
  v_mfma_f32_16x16x32_bf16 v[68:71], v[88:91], v[88:91], v[68:71]
  buffer_load_dwordx4 v29, s[8:11], s66 offen offset:3072 sc1 lds
  v_mfma_f32_16x16x32_bf16 v[64:67], v[72:75], v[88:91], v[64:67]
  s_waitcnt lgkmcnt(0)
  v_max3_u32 v30, v112, v114, v116
  v_mfma_f32_16x16x32_bf16 v[32:35], a[32:35], v[88:91], v[32:35]
  ds_read_b64_tr_b16 a[0:1], v12 offset:45056
  v_max_u32 v30, v30, v118
  v_mfma_f32_16x16x32_bf16 v[36:39], a[36:39], v[88:91], v[36:39]
  ds_read_b64_tr_b16 a[2:3], v12 offset:47104
  v_cmp_eq_u32 vcc, -1, v30
  v_mfma_f32_16x16x32_bf16 v[40:43], a[40:43], v[88:91], v[40:43]
  ds_read_b64_tr_b16 a[4:5], v13 offset:45056
  v_mfma_f32_16x16x32_bf16 v[44:47], a[44:47], v[88:91], v[44:47]
  s_cbranch_vccnz Lretry15
Lcont16:
  s_barrier
  v_mfma_f32_16x16x32_bf16 v[68:71], v[92:95], v[92:95], v[68:71]
  ds_read_b64_tr_b16 a[6:7], v13 offset:47104
  v_mfma_f32_16x16x32_bf16 v[64:67], v[72:75], v[92:95], v[64:67]
  ds_read_b64_tr_b16 v[96:97], v16 offset:16384
  ds_read_b64_tr_b16 v[98:99], v16 offset:18432
  v_mfma_f32_16x16x32_bf16 v[32:35], a[48:51], v[92:95], v[32:35]
  ds_read_b64_tr_b16 a[8:9], v14 offset:45056
  v_mfma_f32_16x16x32_bf16 v[36:39], a[52:55], v[92:95], v[36:39]
  ds_read_b64_tr_b16 a[10:11], v14 offset:47104
  ds_read_b64_tr_b16 a[12:13], v15 offset:45056
  ds_read_b64_tr_b16 a[14:15], v15 offset:47104
  v_mfma_f32_16x16x32_bf16 v[40:43], a[56:59], v[92:95], v[40:43]
  ds_read_b64_tr_b16 v[100:101], v16 offset:20480
  v_mfma_f32_16x16x32_bf16 v[44:47], a[60:63], v[92:95], v[44:47]
  s_waitcnt lgkmcnt(5)
  ds_read_b64_tr_b16 a[16:17], v12 offset:49152
  v_mfma_f32_16x16x32_bf16 v[68:71], v[96:99], v[96:99], v[68:71]
  ds_read_b64_tr_b16 v[102:103], v16 offset:22528
  s_add_u32 m0, s78, 0
  s_add_u32 s67, s69, 0
  v_mfma_f32_16x16x32_bf16 v[64:67], v[72:75], v[96:99], v[64:67]
  buffer_load_dwordx4 v4, s[20:23], s67 offen lds
  v_mfma_f32_16x16x32_bf16 v[32:35], a[64:67], v[96:99], v[32:35]
  ds_read_b64_tr_b16 a[18:19], v12 offset:51200
  ds_read_b64_tr_b16 a[20:21], v13 offset:49152
  v_mfma_f32_16x16x32_bf16 v[36:39], a[68:71], v[96:99], v[36:39]
  ds_read_b64_tr_b16 a[22:23], v13 offset:51200
  ds_read_b64_tr_b16 v[104:105], v16 offset:24576
  v_mfma_f32_16x16x32_bf16 v[40:43], a[72:75], v[96:99], v[40:43]
  ds_read_b64_tr_b16 a[24:25], v14 offset:49152
  s_add_u32 m0, s78, 4096
  v_mfma_f32_16x16x32_bf16 v[44:47], a[76:79], v[96:99], v[44:47]
  s_waitcnt lgkmcnt(5)
  ds_read_b64_tr_b16 a[26:27], v14 offset:51200
  ds_read_b64_tr_b16 a[28:29], v15 offset:49152
  ds_read_b64_tr_b16 a[30:31], v15 offset:51200
  v_mfma_f32_16x16x32_bf16 v[68:71], v[100:103], v[100:103], v[68:71]
  s_mul_i32 s58, s2, 5504
  v_min_u32 v6, 42, v0
  v_lshlrev_b32 v6, 7, v6
  buffer_load_dword v7, v6, s[28:31], s58 offen
  v_mfma_f32_16x16x32_bf16 v[64:67], v[72:75], v[100:103], v[64:67]
  ds_read_b64_tr_b16 v[106:107], v16 offset:26624
  s_add_u32 s67, s69, 32768
  buffer_load_dwordx4 v4, s[20:23], s67 offen lds
  v_mfma_f32_16x16x32_bf16 v[32:35], a[80:83], v[100:103], v[32:35]
  s_waitcnt vmcnt(7)
  ds_read_b64 v[112:113], v17 offset:32768
  ds_read_b64_tr_b16 a[32:33], v12 offset:53248
  v_mfma_f32_16x16x32_bf16 v[36:39], a[84:87], v[100:103], v[36:39]
  ds_read_b64 v[114:115], v17 offset:33792
  ds_read_b64 v[116:117], v17 offset:34816
  ds_read_b64 v[118:119], v17 offset:35840
  v_mfma_f32_16x16x32_bf16 v[40:43], a[88:91], v[100:103], v[40:43]
  ds_read_b64_tr_b16 v[108:109], v16 offset:28672
  ds_read_b64_tr_b16 a[34:35], v12 offset:55296
  s_add_u32 m0, s78, 8192
  v_mfma_f32_16x16x32_bf16 v[44:47], a[92:95], v[100:103], v[44:47]
  s_waitcnt lgkmcnt(7)
  ds_read_b64_tr_b16 v[110:111], v16 offset:30720
  ds_read_b64_tr_b16 a[36:37], v13 offset:53248
  v_mfma_f32_16x16x32_bf16 v[68:71], v[104:107], v[104:107], v[68:71]
  ds_read_b64_tr_b16 a[38:39], v13 offset:55296
  ds_read_b64_tr_b16 a[40:41], v14 offset:53248
  s_add_u32 s67, s69, 65536
  buffer_load_dwordx4 v4, s[20:23], s67 offen lds
  v_mfma_f32_16x16x32_bf16 v[64:67], v[72:75], v[104:107], v[64:67]
  ds_read_b64_tr_b16 a[42:43], v14 offset:55296
  ds_read_b64_tr_b16 a[44:45], v15 offset:53248
  ds_read_b64_tr_b16 a[46:47], v15 offset:55296
  v_mfma_f32_16x16x32_bf16 v[32:35], a[96:99], v[104:107], v[32:35]
  s_waitcnt lgkmcnt(9)
  v_max3_u32 v30, v112, v114, v116
  v_max_u32 v30, v30, v118
  v_mfma_f32_16x16x32_bf16 v[36:39], a[100:103], v[104:107], v[36:39]
  ds_read_b64_tr_b16 a[48:49], v12 offset:57344
  s_add_u32 m0, s78, 12288
  v_cmp_eq_u32 vcc, -1, v30
  v_mfma_f32_16x16x32_bf16 v[40:43], a[104:107], v[104:107], v[40:43]
  ds_read_b64_tr_b16 a[50:51], v12 offset:59392
  s_add_u32 s67, s69, 98304
  v_mfma_f32_16x16x32_bf16 v[44:47], a[108:111], v[104:107], v[44:47]
  s_waitcnt lgkmcnt(8)
  s_cbranch_vccnz Lretry17
Lcont18:
  s_barrier
  v_mfma_f32_16x16x32_bf16 v[68:71], v[108:111], v[108:111], v[68:71]
  buffer_load_dwordx4 v4, s[20:23], s67 offen lds
  v_mfma_f32_16x16x32_bf16 v[64:67], v[72:75], v[108:111], v[64:67]
  ds_read_b64_tr_b16 v[80:81], v16 offset:32768
  ds_read_b64_tr_b16 v[82:83], v16 offset:34816
  v_mfma_f32_16x16x32_bf16 v[32:35], a[112:115], v[108:111], v[32:35]
Lpage3:
  s_cbranch_execz Lback3
  ds_read_b64_tr_b16 a[52:53], v13 offset:57344
  ds_read_b64_tr_b16 a[54:55], v13 offset:59392
  v_mfma_f32_16x16x32_bf16 v[36:39], a[116:119], v[108:111], v[36:39]
  ds_read_b64_tr_b16 a[56:57], v14 offset:57344
  ds_read_b64_tr_b16 a[58:59], v14 offset:59392
  ds_read_b64_tr_b16 a[60:61], v15 offset:57344
  ds_read_b64_tr_b16 a[62:63], v15 offset:59392
  v_mfma_f32_16x16x32_bf16 v[40:43], a[120:123], v[108:111], v[40:43]
  ds_read_b64_tr_b16 v[84:85], v16 offset:36864
  s_add_u32 m0, s79, 16384
  s_add_u32 s67, s77, 131072
  v_mfma_f32_16x16x32_bf16 v[44:47], a[124:127], v[108:111], v[44:47]
  s_waitcnt lgkmcnt(7)
  buffer_load_dwordx4 v4, s[20:23], s67 offen lds
  v_mfma_f32_16x16x32_bf16 v[68:71], v[80:83], v[80:83], v[68:71]
  ds_read_b64_tr_b16 a[64:65], v12 offset:61440
  v_mfma_f32_16x16x32_bf16 v[64:67], v[72:75], v[80:83], v[64:67]
  ds_read_b64_tr_b16 v[86:87], v16 offset:38912
  ds_read_b64_tr_b16 a[66:67], v12 offset:63488
  v_mfma_f32_16x16x32_bf16 v[32:35], a[128:131], v[80:83], v[32:35]
  ds_read_b64_tr_b16 v[172:173], v19 offset:27648
  ds_read_b64_tr_b16 a[68:69], v13 offset:61440
  v_mfma_f32_16x16x32_bf16 v[36:39], a[132:135], v[80:83], v[36:39]
  ds_read_b64_tr_b16 a[70:71], v13 offset:63488
  ds_read_b64_tr_b16 v[88:89], v16 offset:40960
  s_add_u32 m0, s79, 20480
  v_mfma_f32_16x16x32_bf16 v[40:43], a[136:139], v[80:83], v[40:43]
  ds_read_b64_tr_b16 a[72:73], v14 offset:61440
  ds_read_b64_tr_b16 v[174:175], v19 offset:29184
  s_add_u32 s67, s77, 163840
  v_mfma_f32_16x16x32_bf16 v[44:47], a[140:143], v[80:83], v[44:47]
  s_waitcnt lgkmcnt(7)
  ds_read_b64_tr_b16 a[74:75], v14 offset:63488
  ds_read_b64_tr_b16 a[76:77], v15 offset:61440
  ds_read_b64_tr_b16 a[78:79], v15 offset:63488
  buffer_load_dwordx4 v4, s[20:23], s67 offen lds
  v_mfma_f32_16x16x32_bf16 v[68:71], v[84:87], v[84:87], v[68:71]
  s_waitcnt vmcnt(7)
  ds_read_b64 v[112:113], v17 offset:49152
  ds_read_b64 v[114:115], v17 offset:50176
  ds_read_b64 v[116:117], v17 offset:51200
  ds_read_b64 v[118:119], v17 offset:52224
  v_mfma_f32_16x16x32_bf16 v[64:67], v[72:75], v[84:87], v[64:67]
  ds_read_b64_tr_b16 v[90:91], v16 offset:43008
  ds_read_b64_tr_b16 v[176:177], v19 offset:27680
  v_mfma_f32_16x16x32_bf16 v[32:35], a[144:147], v[84:87], v[32:35]
  ds_read_b64_tr_b16 v[92:93], v16 offset:45056
  s_add_u32 m0, s79, 24576
  v_mfma_f32_16x16x32_bf16 v[36:39], a[148:151], v[84:87], v[36:39]
  ds_read_b64_tr_b16 v[178:179], v19 offset:29216
  s_add_u32 s67, s77, 196608
  v_mfma_f32_16x16x32_bf16 v[40:43], a[152:155], v[84:87], v[40:43]
  buffer_load_dwordx4 v4, s[20:23], s67 offen lds
  v_mfma_f32_16x16x32_bf16 v[44:47], a[156:159], v[84:87], v[44:47]
  s_waitcnt lgkmcnt(3)
  ds_read_b64_tr_b16 v[94:95], v16 offset:47104
  v_mfma_f32_16x16x32_bf16 v[68:71], v[88:91], v[88:91], v[68:71]
  v_max3_u32 v30, v112, v114, v116
  v_max_u32 v30, v30, v118
  v_mfma_f32_16x16x32_bf16 v[64:67], v[72:75], v[88:91], v[64:67]
  ds_read_b64_tr_b16 v[180:181], v19 offset:27712
  s_add_u32 m0, s79, 28672
  v_cmp_eq_u32 vcc, -1, v30
  v_mfma_f32_16x16x32_bf16 v[32:35], a[160:163], v[88:91], v[32:35]
  s_cbranch_vccnz Lretry19
Lcont20:
  s_barrier
  v_mfma_f32_16x16x32_bf16 v[36:39], a[164:167], v[88:91], v[36:39]
  ds_read_b64_tr_b16 v[182:183], v19 offset:29248
  s_add_u32 s67, s77, 229376
  v_mfma_f32_16x16x32_bf16 v[40:43], a[168:171], v[88:91], v[40:43]
  ds_read_b64_tr_b16 v[96:97], v16 offset:49152
  ds_read_b64_tr_b16 v[98:99], v16 offset:51200
  buffer_load_dwordx4 v4, s[20:23], s67 offen lds
  v_mfma_f32_16x16x32_bf16 v[44:47], a[172:175], v[88:91], v[44:47]
  s_waitcnt lgkmcnt(4)
  ds_read_b128 v[48:51], v31 offset:0
  v_mfma_f32_16x16x32_bf16 v[68:71], v[92:95], v[92:95], v[68:71]
  ds_read_b128 v[52:55], v31 offset:1024
  v_mfma_f32_16x16x32_bf16 v[64:67], v[72:75], v[92:95], v[64:67]
  ds_read_b64_tr_b16 v[184:185], v19 offset:24576
  ds_read_b64_tr_b16 v[100:101], v16 offset:53248
  v_mfma_f32_16x16x32_bf16 v[32:35], a[0:3], v[92:95], v[32:35]
  ds_read_b64_tr_b16 v[102:103], v16 offset:55296
  ds_read_b128 v[56:59], v31 offset:2048
  v_mfma_f32_16x16x32_bf16 v[36:39], a[4:7], v[92:95], v[36:39]
  ds_read_b128 v[60:63], v31 offset:3072
  ds_read_b64_tr_b16 v[104:105], v16 offset:57344
  v_mfma_f32_16x16x32_bf16 v[40:43], a[8:11], v[92:95], v[40:43]
  ds_read_b64_tr_b16 v[106:107], v16 offset:59392
  ds_read_b64_tr_b16 v[108:109], v16 offset:61440
  ds_read_b64_tr_b16 v[110:111], v16 offset:63488
  v_mfma_f32_16x16x32_bf16 v[44:47], a[12:15], v[92:95], v[44:47]
  s_waitcnt lgkmcnt(11)
  ds_read_b64_tr_b16 v[186:187], v19 offset:26112
  s_add_u32 m0, s78, 32768
  v_mfma_f32_16x16x32_bf16 v[68:71], v[96:99], v[96:99], v[68:71]
  s_add_u32 s67, s69, 262144
  buffer_load_dwordx4 v4, s[20:23], s67 offen lds
  v_mfma_f32_16x16x32_bf16 v[64:67], v[72:75], v[96:99], v[64:67]
  s_waitcnt lgkmcnt(7)
  ds_read_b64_tr_b16 v[188:189], v19 offset:24608
  v_mfma_f32_16x16x32_bf16 v[68:71], v[100:103], v[100:103], v[68:71]
  ds_read_b64_tr_b16 v[136:137], v129 offset:0
  s_add_u32 m0, s78, 36864
  v_mfma_f32_16x16x32_bf16 v[64:67], v[72:75], v[100:103], v[64:67]
  s_waitcnt lgkmcnt(5)
  ds_read_b64_tr_b16 v[190:191], v19 offset:26144
  s_add_u32 s67, s69, 294912
  v_mfma_f32_16x16x32_bf16 v[68:71], v[104:107], v[104:107], v[68:71]
  ds_read_b64_tr_b16 v[138:139], v129 offset:16384
  v_mfma_f32_16x16x32_bf16 v[64:67], v[72:75], v[104:107], v[64:67]
  s_waitcnt lgkmcnt(5)
  ds_read_b64_tr_b16 v[140:141], v129 offset:32768
  ds_read_b64_tr_b16 v[142:143], v129 offset:49152
  buffer_load_dwordx4 v4, s[20:23], s67 offen lds
  v_mfma_f32_16x16x32_bf16 v[68:71], v[108:111], v[108:111], v[68:71]
  ds_read_b64_tr_b16 v[192:193], v19 offset:24640
  v_mfma_f32_16x16x32_bf16 v[64:67], v[72:75], v[108:111], v[64:67]
  ds_read_b64_tr_b16 v[194:195], v19 offset:26176
  v_mfma_f32_16x16x32_bf16 v[32:35], a[16:19], v[96:99], v[32:35]
  s_add_u32 m0, s78, 40960
  v_mfma_f32_16x16x32_bf16 v[36:39], a[20:23], v[96:99], v[36:39]
  s_add_u32 s67, s69, 327680
  v_mfma_f32_16x16x32_bf16 v[40:43], a[24:27], v[96:99], v[40:43]
  buffer_load_dwordx4 v4, s[20:23], s67 offen lds
  v_mfma_f32_16x16x32_bf16 v[44:47], a[28:31], v[96:99], v[44:47]
  v_mul_f32 v86, v68, v76
  v_fmac_f32 v86, v69, v77
  v_mfma_f32_16x16x32_bf16 v[32:35], a[32:35], v[100:103], v[32:35]
  v_fmac_f32 v86, v70, v78
  v_fmac_f32 v86, v71, v79
  v_mfma_f32_16x16x32_bf16 v[36:39], a[36:39], v[100:103], v[36:39]
  v_mov_b32 v87, v86
  v_mul_f32 v80, 0x3b000000, v64
  v_mfma_f32_16x16x32_bf16 v[40:43], a[40:43], v[100:103], v[40:43]
  s_add_u32 m0, s78, 45056
  v_permlane32_swap_b32 v86, v87
  s_nop 0
  v_add_f32 v86, v86, v87
  v_mfma_f32_16x16x32_bf16 v[44:47], a[44:47], v[100:103], v[44:47]
  s_add_u32 s67, s69, 360448
  v_mov_b32 v87, v86
  s_nop 1
  v_permlane16_swap_b32 v86, v87
  v_mfma_f32_16x16x32_bf16 v[32:35], a[48:51], v[104:107], v[32:35]
  buffer_load_dwordx4 v4, s[20:23], s67 offen lds
  v_mfma_f32_16x16x32_bf16 v[36:39], a[52:55], v[104:107], v[36:39]
  v_add_f32 v86, v86, v87
  v_mul_f32 v86, 0x3b000000, v86
  v_mfma_f32_16x16x32_bf16 v[40:43], a[56:59], v[104:107], v[40:43]
  v_fma_f32 v86, -v80, v80, v86
  v_max_f32 v86, 0, v86
  v_mfma_f32_16x16x32_bf16 v[44:47], a[60:63], v[104:107], v[44:47]
  v_add_f32 v81, 0x3727c5ac, v86
  v_mul_f32 v87, 0x3727c5ac, v81
  v_mfma_f32_16x16x32_bf16 v[32:35], a[64:67], v[108:111], v[32:35]
  v_add_f32 v86, v86, v87
  v_mfma_f32_16x16x32_bf16 v[36:39], a[68:71], v[108:111], v[36:39]
  v_rsq_f32 v87, v86
  v_mfma_f32_16x16x32_bf16 v[40:43], a[72:75], v[108:111], v[40:43]
  v_rsq_f32 v81, v81
  v_mfma_f32_16x16x32_bf16 v[44:47], a[76:79], v[108:111], v[44:47]
  v_mul_f32 v84, v86, v87
  v_mul_f32 v82, s74, v87
  v_mul_f32 v86, v87, v87
  v_mul_f32 v83, s75, v87
  v_mul_f32 v83, v83, v86
  s_add_u32 m0, s79, 49152
  s_add_u32 s67, s77, 393216
  buffer_load_dwordx4 v4, s[20:23], s67 offen lds
.p2align 3
  v_pk_fma_f32 v[32:33], v[48:49], v[80:81], v[32:33] op_sel_hi:[1,0,1] neg_lo:[0,1,0] neg_hi:[0,1,0]
  v_pk_fma_f32 v[34:35], v[50:51], v[80:81], v[34:35] op_sel_hi:[1,0,1] neg_lo:[0,1,0] neg_hi:[0,1,0]
  v_pk_fma_f32 v[36:37], v[52:53], v[80:81], v[36:37] op_sel_hi:[1,0,1] neg_lo:[0,1,0] neg_hi:[0,1,0]
  v_pk_fma_f32 v[38:39], v[54:55], v[80:81], v[38:39] op_sel_hi:[1,0,1] neg_lo:[0,1,0] neg_hi:[0,1,0]
  v_pk_mul_f32 v[96:97], v[32:33], v[32:33]
  v_pk_mul_f32 v[98:99], v[34:35], v[34:35]
  v_pk_mul_f32 v[100:101], v[36:37], v[36:37]
  v_pk_mul_f32 v[102:103], v[38:39], v[38:39]
  v_pk_fma_f32 v[96:97], v[96:97], v[82:83], v[82:83] op_sel:[0,1,0] op_sel_hi:[1,1,0]
  v_pk_fma_f32 v[98:99], v[98:99], v[82:83], v[82:83] op_sel:[0,1,0] op_sel_hi:[1,1,0]
  v_pk_fma_f32 v[100:101], v[100:101], v[82:83], v[82:83] op_sel:[0,1,0] op_sel_hi:[1,1,0]
  v_pk_fma_f32 v[102:103], v[102:103], v[82:83], v[82:83] op_sel:[0,1,0] op_sel_hi:[1,1,0]
  v_pk_mul_f32 v[96:97], v[96:97], v[32:33]
  v_pk_mul_f32 v[98:99], v[98:99], v[34:35]
  v_pk_mul_f32 v[100:101], v[100:101], v[36:37]
  v_pk_mul_f32 v[102:103], v[102:103], v[38:39]
  v_exp_f32 v96, v96
  v_exp_f32 v97, v97
  v_exp_f32 v98, v98
  s_add_u32 m0, s79, 53248
  s_add_u32 s67, s77, 425984
  buffer_load_dwordx4 v4, s[20:23], s67 offen lds
  v_exp_f32 v99, v99
  v_exp_f32 v100, v100
  v_exp_f32 v101, v101
  v_exp_f32 v102, v102
  v_exp_f32 v103, v103
  v_pk_fma_f32 v[96:97], v[96:97], v[84:85], v[84:85] op_sel_hi:[1,0,0]
  v_pk_fma_f32 v[98:99], v[98:99], v[84:85], v[84:85] op_sel_hi:[1,0,0]
  v_pk_fma_f32 v[100:101], v[100:101], v[84:85], v[84:85] op_sel_hi:[1,0,0]
  v_pk_fma_f32 v[102:103], v[102:103], v[84:85], v[84:85] op_sel_hi:[1,0,0]
  v_rcp_f32 v96, v96
  v_rcp_f32 v97, v97
  v_rcp_f32 v98, v98
  v_rcp_f32 v99, v99
  v_rcp_f32 v100, v100
  v_rcp_f32 v101, v101
  v_rcp_f32 v102, v102
  v_rcp_f32 v103, v103
  v_pk_mul_f32 v[96:97], v[96:97], v[32:33]
  v_pk_mul_f32 v[98:99], v[98:99], v[34:35]
  v_pk_mul_f32 v[100:101], v[100:101], v[36:37]
  v_pk_mul_f32 v[102:103], v[102:103], v[38:39]
  s_add_u32 m0, s79, 57344
  s_add_u32 s67, s77, 458752
  buffer_load_dwordx4 v4, s[20:23], s67 offen lds
  v_cvt_pk_bf16_f32 v88, v96, v97
  v_cvt_pk_bf16_f32 v89, v98, v99
  v_cvt_pk_bf16_f32 v90, v100, v101
  v_cvt_pk_bf16_f32 v91, v102, v103
  buffer_store_dwordx4 v[88:91], v128, s[8:11], s12 offen sc1
  v_pk_fma_f32 v[40:41], v[56:57], v[80:81], v[40:41] op_sel_hi:[1,0,1] neg_lo:[0,1,0] neg_hi:[0,1,0]
  v_pk_fma_f32 v[42:43], v[58:59], v[80:81], v[42:43] op_sel_hi:[1,0,1] neg_lo:[0,1,0] neg_hi:[0,1,0]
  v_pk_fma_f32 v[44:45], v[60:61], v[80:81], v[44:45] op_sel_hi:[1,0,1] neg_lo:[0,1,0] neg_hi:[0,1,0]
  v_pk_fma_f32 v[46:47], v[62:63], v[80:81], v[46:47] op_sel_hi:[1,0,1] neg_lo:[0,1,0] neg_hi:[0,1,0]
  v_pk_mul_f32 v[104:105], v[40:41], v[40:41]
  v_pk_mul_f32 v[106:107], v[42:43], v[42:43]
  v_pk_mul_f32 v[108:109], v[44:45], v[44:45]
  v_pk_mul_f32 v[110:111], v[46:47], v[46:47]
  v_pk_fma_f32 v[104:105], v[104:105], v[82:83], v[82:83] op_sel:[0,1,0] op_sel_hi:[1,1,0]
  v_pk_fma_f32 v[106:107], v[106:107], v[82:83], v[82:83] op_sel:[0,1,0] op_sel_hi:[1,1,0]
  v_pk_fma_f32 v[108:109], v[108:109], v[82:83], v[82:83] op_sel:[0,1,0] op_sel_hi:[1,1,0]
  v_pk_fma_f32 v[110:111], v[110:111], v[82:83], v[82:83] op_sel:[0,1,0] op_sel_hi:[1,1,0]
  v_pk_mul_f32 v[104:105], v[104:105], v[40:41]
  v_pk_mul_f32 v[106:107], v[106:107], v[42:43]
  v_pk_mul_f32 v[108:109], v[108:109], v[44:45]
  v_pk_mul_f32 v[110:111], v[110:111], v[46:47]
  s_add_u32 m0, s79, 61440
  s_add_u32 s67, s77, 491520
  buffer_load_dwordx4 v4, s[20:23], s67 offen lds
  v_exp_f32 v104, v104
  v_exp_f32 v105, v105
  v_exp_f32 v106, v106
  v_exp_f32 v107, v107
  v_exp_f32 v108, v108
  v_exp_f32 v109, v109
  v_exp_f32 v110, v110
  v_exp_f32 v111, v111
  v_pk_fma_f32 v[104:105], v[104:105], v[84:85], v[84:85] op_sel_hi:[1,0,0]
  v_pk_fma_f32 v[106:107], v[106:107], v[84:85], v[84:85] op_sel_hi:[1,0,0]
  v_pk_fma_f32 v[108:109], v[108:109], v[84:85], v[84:85] op_sel_hi:[1,0,0]
  v_pk_fma_f32 v[110:111], v[110:111], v[84:85], v[84:85] op_sel_hi:[1,0,0]
  v_rcp_f32 v104, v104
  v_rcp_f32 v105, v105
  v_rcp_f32 v106, v106
  v_rcp_f32 v107, v107
  v_rcp_f32 v108, v108
  v_rcp_f32 v109, v109
  v_rcp_f32 v110, v110
  v_rcp_f32 v111, v111
  v_pk_mul_f32 v[104:105], v[104:105], v[40:41]
  v_pk_mul_f32 v[106:107], v[106:107], v[42:43]
  v_pk_mul_f32 v[108:109], v[108:109], v[44:45]
  v_pk_mul_f32 v[110:111], v[110:111], v[46:47]
  v_cvt_pk_bf16_f32 v92, v104, v105
  v_cvt_pk_bf16_f32 v93, v106, v107
  v_cvt_pk_bf16_f32 v94, v108, v109
  v_cvt_pk_bf16_f32 v95, v110, v111
  buffer_store_dwordx4 v[92:95], v128, s[8:11], s13 offen sc1
  s_add_u32 s60, s60, 65536
  v_add_u32 v25, 65536, v25
  s_mov_b32 s66, s14
  v_bfrev_b32 v17, 1
  s_waitcnt lgkmcnt(2)
  v_mul_f32 v80, v80, v81
  v_lshlrev_b32 v32, 16, v136
  v_and_b32 v33, s73, v136
  v_lshlrev_b32 v34, 16, v137
  v_and_b32 v35, s73, v137
  v_lshlrev_b32 v36, 16, v138
  v_and_b32 v37, s73, v138
  v_lshlrev_b32 v38, 16, v139
  v_and_b32 v39, s73, v139
  v_lshlrev_b32 v40, 16, v140
  v_and_b32 v41, s73, v140
  v_lshlrev_b32 v42, 16, v141
  v_and_b32 v43, s73, v141
  v_lshlrev_b32 v44, 16, v142
  v_and_b32 v45, s73, v142
  v_lshlrev_b32 v46, 16, v143
  v_and_b32 v47, s73, v143
  v_pk_fma_f32 v[32:33], v[32:33], v[80:81], v[80:81] op_sel:[0,1,0] op_sel_hi:[1,1,0] neg_lo:[0,0,1] neg_hi:[0,0,1]
  v_pk_fma_f32 v[34:35], v[34:35], v[80:81], v[80:81] op_sel:[0,1,0] op_sel_hi:[1,1,0] neg_lo:[0,0,1] neg_hi:[0,0,1]
  v_pk_fma_f32 v[36:37], v[36:37], v[80:81], v[80:81] op_sel:[0,1,0] op_sel_hi:[1,1,0] neg_lo:[0,0,1] neg_hi:[0,0,1]
  v_pk_fma_f32 v[38:39], v[38:39], v[80:81], v[80:81] op_sel:[0,1,0] op_sel_hi:[1,1,0] neg_lo:[0,0,1] neg_hi:[0,0,1]
  v_pk_fma_f32 v[40:41], v[40:41], v[80:81], v[80:81] op_sel:[0,1,0] op_sel_hi:[1,1,0] neg_lo:[0,0,1] neg_hi:[0,0,1]
  v_pk_fma_f32 v[42:43], v[42:43], v[80:81], v[80:81] op_sel:[0,1,0] op_sel_hi:[1,1,0] neg_lo:[0,0,1] neg_hi:[0,0,1]
  v_pk_fma_f32 v[44:45], v[44:45], v[80:81], v[80:81] op_sel:[0,1,0] op_sel_hi:[1,1,0] neg_lo:[0,0,1] neg_hi:[0,0,1]
  v_pk_fma_f32 v[46:47], v[46:47], v[80:81], v[80:81] op_sel:[0,1,0] op_sel_hi:[1,1,0] neg_lo:[0,0,1] neg_hi:[0,0,1]
  v_add_u32 v30, s66, v20
  s_lshl_b32 s67, s3, 8
  v_lshl_add_u32 v16, v20, 4, s67
  v_add_u32 v16, v2, v16
  v_cmp_le_u32 vcc, 1, v30
  s_nop 1
  v_cndmask_b32 v26, v17, v16, vcc
  v_cmp_gt_u32 vcc, 2047, v30
  s_nop 1
  v_cndmask_b32 v27, v17, v16, vcc
  v_cmp_le_u32 vcc, 2, v30
  s_nop 1
  v_cndmask_b32 v28, v17, v16, vcc
  v_cmp_gt_u32 vcc, 2046, v30
  s_nop 1
  v_cndmask_b32 v29, v17, v16, vcc
  s_lshl_b32 s67, s66, 7
  v_lshl_add_u32 v18, v20, 4, s67
  s_and_b32 s64, s5, 3
  s_mul_i32 s64, s64, 1056768
  s_lshr_b32 s65, s5, 2
  s_lshl_b32 s65, s65, 11
  s_add_u32 s64, s64, s65
  s_add_u32 s64, s64, 1048576
  s_waitcnt vmcnt(1)
  s_barrier
  ds_read_b64_tr_b16 a[0:1], v12 offset:0
  s_add_u32 m0, s60, 0
  s_add_u32 s63, s62, 968704
  buffer_load_dwordx4 v22, s[24:27], s63 offen lds
  ds_read_b64_tr_b16 a[2:3], v12 offset:2048
  ds_read_b64_tr_b16 a[4:5], v13 offset:0
  ds_read_b64_tr_b16 a[6:7], v13 offset:2048
  ds_read_b64_tr_b16 a[8:9], v14 offset:0
  ds_read_b64_tr_b16 a[10:11], v14 offset:2048
  ds_read_b64_tr_b16 a[12:13], v15 offset:0
  buffer_load_dwordx4 v23, s[24:27], s63 offen offset:1024 lds
  ds_read_b64_tr_b16 a[14:15], v15 offset:2048
  ds_read_b64_tr_b16 a[16:17], v12 offset:4096
  ds_read_b64_tr_b16 a[18:19], v12 offset:6144
  ds_read_b64_tr_b16 a[20:21], v13 offset:4096
  ds_read_b64_tr_b16 a[22:23], v13 offset:6144
  ds_read_b64_tr_b16 a[24:25], v14 offset:4096
  ds_read_b64_tr_b16 a[26:27], v14 offset:6144
  buffer_load_dwordx4 v24, s[24:27], s63 offen offset:2048 lds
  ds_read_b64_tr_b16 a[28:29], v15 offset:4096
  ds_read_b64_tr_b16 a[30:31], v15 offset:6144
  ds_read_b64_tr_b16 a[32:33], v12 offset:8192
  ds_read_b64_tr_b16 a[34:35], v12 offset:10240
  ds_read_b64_tr_b16 a[36:37], v13 offset:8192
  ds_read_b64_tr_b16 a[38:39], v13 offset:10240
  s_add_u32 m0, s60, 3072
  s_add_u32 s63, s76, 1056768
  buffer_load_dwordx4 v22, s[24:27], s63 offen lds
  ds_read_b64_tr_b16 a[40:41], v14 offset:8192
  ds_read_b64_tr_b16 a[42:43], v14 offset:10240
  ds_read_b64_tr_b16 a[44:45], v15 offset:8192
  ds_read_b64_tr_b16 a[46:47], v15 offset:10240
  ds_read_b64_tr_b16 a[48:49], v12 offset:12288
  ds_read_b64_tr_b16 a[50:51], v12 offset:14336
  ds_read_b64_tr_b16 a[52:53], v13 offset:12288
  buffer_load_dwordx4 v23, s[24:27], s63 offen offset:1024 lds
  ds_read_b64_tr_b16 a[54:55], v13 offset:14336
  ds_read_b64_tr_b16 a[56:57], v14 offset:12288
  ds_read_b64_tr_b16 a[58:59], v14 offset:14336
  ds_read_b64_tr_b16 a[60:61], v15 offset:12288
  ds_read_b64_tr_b16 a[62:63], v15 offset:14336
  ds_read_b64_tr_b16 a[64:65], v12 offset:16384
  ds_read_b64_tr_b16 a[66:67], v12 offset:18432
  buffer_load_dwordx4 v24, s[24:27], s63 offen offset:2048 lds
  ds_read_b64_tr_b16 a[68:69], v13 offset:16384
  ds_read_b64_tr_b16 a[70:71], v13 offset:18432
  ds_read_b64_tr_b16 a[72:73], v14 offset:16384
  ds_read_b64_tr_b16 a[74:75], v14 offset:18432
  ds_read_b64_tr_b16 a[76:77], v15 offset:16384
  ds_read_b64_tr_b16 a[78:79], v15 offset:18432
  s_waitcnt vmcnt(6)
  s_add_u32 s65, s64, 0
  buffer_load_dwordx4 v[64:67], v26, s[8:11], s65 offen sc1
  ds_read_b64_tr_b16 a[80:81], v12 offset:20480
  ds_read_b64_tr_b16 a[82:83], v12 offset:22528
  ds_read_b64_tr_b16 a[84:85], v13 offset:20480
  ds_read_b64_tr_b16 a[86:87], v13 offset:22528
  s_add_u32 s65, s64, 33024
  buffer_load_dwordx4 v[68:71], v26, s[8:11], s65 offen sc1
  ds_read_b64_tr_b16 a[88:89], v14 offset:20480
  ds_read_b64_tr_b16 a[90:91], v14 offset:22528
  ds_read_b64_tr_b16 a[92:93], v15 offset:20480
  ds_read_b64_tr_b16 a[94:95], v15 offset:22528
  s_add_u32 s65, s64, 66048
  buffer_load_dwordx4 v[72:75], v26, s[8:11], s65 offen sc1
  ds_read_b64_tr_b16 a[96:97], v12 offset:24576
  ds_read_b64_tr_b16 a[98:99], v12 offset:26624
  s_add_u32 s65, s64, 99072
  buffer_load_dwordx4 v[76:79], v26, s[8:11], s65 offen sc1
  ds_read_b64_tr_b16 a[100:101], v13 offset:24576
  ds_read_b64_tr_b16 a[102:103], v13 offset:26624
  ds_read_b64_tr_b16 a[104:105], v14 offset:24576
  ds_read_b64_tr_b16 a[106:107], v14 offset:26624
  s_add_u32 s65, s64, 132096
  buffer_load_dwordx4 v[80:83], v27, s[8:11], s65 offen sc1
  ds_read_b64_tr_b16 a[108:109], v15 offset:24576
  ds_read_b64_tr_b16 a[110:111], v15 offset:26624
  s_add_u32 s65, s64, 165120
  buffer_load_dwordx4 v[84:87], v27, s[8:11], s65 offen sc1
  ds_read_b64_tr_b16 a[112:113], v12 offset:28672
  ds_read_b64_tr_b16 a[114:115], v12 offset:30720
  ds_read_b64_tr_b16 a[116:117], v13 offset:28672
  ds_read_b64_tr_b16 a[118:119], v13 offset:30720
  s_add_u32 s65, s64, 198144
  buffer_load_dwordx4 v[88:91], v27, s[8:11], s65 offen sc1
  ds_read_b64_tr_b16 a[120:121], v14 offset:28672
  ds_read_b64_tr_b16 a[122:123], v14 offset:30720
  s_add_u32 s65, s64, 231168
  buffer_load_dwordx4 v[92:95], v27, s[8:11], s65 offen sc1
  ds_read_b64_tr_b16 a[124:125], v15 offset:28672
  ds_read_b64_tr_b16 a[126:127], v15 offset:30720
  ds_read_b64_tr_b16 a[128:129], v12 offset:32768
  ds_read_b64_tr_b16 a[130:131], v12 offset:34816
  s_add_u32 s65, s64, 264192
  buffer_load_dwordx4 v[96:99], v28, s[8:11], s65 offen sc1
  ds_read_b64_tr_b16 a[132:133], v13 offset:32768
  ds_read_b64_tr_b16 a[134:135], v13 offset:34816
  s_add_u32 s65, s64, 297216
  buffer_load_dwordx4 v[100:103], v28, s[8:11], s65 offen sc1
  ds_read_b64_tr_b16 a[136:137], v14 offset:32768
  ds_read_b64_tr_b16 a[138:139], v14 offset:34816
  ds_read_b64_tr_b16 a[140:141], v15 offset:32768
  ds_read_b64_tr_b16 a[142:143], v15 offset:34816
  s_add_u32 s65, s64, 330240
  buffer_load_dwordx4 v[104:107], v28, s[8:11], s65 offen sc1
  ds_read_b64_tr_b16 a[144:145], v12 offset:36864
  ds_read_b64_tr_b16 a[146:147], v12 offset:38912
  s_add_u32 s65, s64, 363264
  buffer_load_dwordx4 v[108:111], v28, s[8:11], s65 offen sc1
  ds_read_b64_tr_b16 a[148:149], v13 offset:36864
  ds_read_b64_tr_b16 a[150:151], v13 offset:38912
  ds_read_b64_tr_b16 a[152:153], v14 offset:36864
  ds_read_b64_tr_b16 a[154:155], v14 offset:38912
  s_add_u32 s65, s64, 396288
  buffer_load_dwordx4 v[112:115], v29, s[8:11], s65 offen sc1
  ds_read_b64_tr_b16 a[156:157], v15 offset:36864
  ds_read_b64_tr_b16 a[158:159], v15 offset:38912
  s_add_u32 s65, s64, 429312
  buffer_load_dwordx4 v[116:119], v29, s[8:11], s65 offen sc1
  ds_read_b64_tr_b16 a[160:161], v12 offset:40960
  ds_read_b64_tr_b16 a[162:163], v12 offset:43008
  ds_read_b64_tr_b16 a[164:165], v13 offset:40960
  ds_read_b64_tr_b16 a[166:167], v13 offset:43008
  s_add_u32 s65, s64, 462336
  buffer_load_dwordx4 v[120:123], v29, s[8:11], s65 offen sc1
  ds_read_b64_tr_b16 a[168:169], v14 offset:40960
  ds_read_b64_tr_b16 a[170:171], v14 offset:43008
  s_add_u32 s65, s64, 495360
  buffer_load_dwordx4 v[124:127], v29, s[8:11], s65 offen sc1
  ds_read_b64_tr_b16 a[172:173], v15 offset:40960
  ds_read_b64_tr_b16 a[174:175], v15 offset:43008
  s_waitcnt vmcnt(12)
  v_max3_u32 v48, v65, v69, v73
  v_max_u32 v48, v48, v77
  v_cmp_eq_u32 vcc, -1, v48
  s_cbranch_vccnz Lretry21
Lcont22:
  s_waitcnt lgkmcnt(14)
  v_mfma_f32_16x16x32_bf16 v[32:35], a[0:3], v[64:67], v[32:35]
  s_add_u32 m0, s60, 6144
  s_add_u32 s63, s76, 1144832
  v_mfma_f32_16x16x32_bf16 v[36:39], a[4:7], v[64:67], v[36:39]
  buffer_load_dwordx4 v22, s[24:27], s63 offen lds
  v_mfma_f32_16x16x32_bf16 v[40:43], a[8:11], v[64:67], v[40:43]
  v_mfma_f32_16x16x32_bf16 v[44:47], a[12:15], v[64:67], v[44:47]
  s_waitcnt lgkmcnt(14)
  v_mfma_f32_16x16x32_bf16 v[32:35], a[16:19], v[68:71], v[32:35]
  ds_read_b64_tr_b16 a[0:1], v12 offset:45056
  v_mfma_f32_16x16x32_bf16 v[36:39], a[20:23], v[68:71], v[36:39]
  ds_read_b64_tr_b16 a[2:3], v12 offset:47104
  v_mfma_f32_16x16x32_bf16 v[40:43], a[24:27], v[68:71], v[40:43]
  ds_read_b64_tr_b16 a[4:5], v13 offset:45056
  v_mfma_f32_16x16x32_bf16 v[44:47], a[28:31], v[68:71], v[44:47]
  s_waitcnt lgkmcnt(14)
  buffer_load_dwordx4 v23, s[24:27], s63 offen offset:1024 lds
  v_mfma_f32_16x16x32_bf16 v[32:35], a[32:35], v[72:75], v[32:35]
  ds_read_b64_tr_b16 a[6:7], v13 offset:47104
  v_mfma_f32_16x16x32_bf16 v[36:39], a[36:39], v[72:75], v[36:39]
  ds_read_b64_tr_b16 a[8:9], v14 offset:45056
  v_mfma_f32_16x16x32_bf16 v[40:43], a[40:43], v[72:75], v[40:43]
  ds_read_b64_tr_b16 a[10:11], v14 offset:47104
  v_mfma_f32_16x16x32_bf16 v[44:47], a[44:47], v[72:75], v[44:47]
  s_waitcnt lgkmcnt(14)
  ds_read_b64_tr_b16 a[12:13], v15 offset:45056
  ds_read_b64_tr_b16 a[14:15], v15 offset:47104
  v_mfma_f32_16x16x32_bf16 v[32:35], a[48:51], v[76:79], v[32:35]
  s_waitcnt vmcnt(10)
  v_max3_u32 v48, v81, v85, v89
  v_max_u32 v48, v48, v93
  v_mfma_f32_16x16x32_bf16 v[36:39], a[52:55], v[76:79], v[36:39]
  buffer_load_dwordx4 v24, s[24:27], s63 offen offset:2048 lds
  v_mfma_f32_16x16x32_bf16 v[40:43], a[56:59], v[76:79], v[40:43]
  ds_read_b64_tr_b16 a[16:17], v12 offset:49152
  ds_read_b64_tr_b16 a[18:19], v12 offset:51200
  v_mfma_f32_16x16x32_bf16 v[44:47], a[60:63], v[76:79], v[44:47]
  s_waitcnt lgkmcnt(14)
  ds_read_b64_tr_b16 a[20:21], v13 offset:49152
  v_cmp_eq_u32 vcc, -1, v48
  s_cbranch_vccnz Lretry23
Lcont24:
  v_mfma_f32_16x16x32_bf16 v[32:35], a[64:67], v[80:83], v[32:35]
  ds_read_b64_tr_b16 a[22:23], v13 offset:51200
  v_mfma_f32_16x16x32_bf16 v[36:39], a[68:71], v[80:83], v[36:39]
  ds_read_b64_tr_b16 a[24:25], v14 offset:49152
  v_mfma_f32_16x16x32_bf16 v[40:43], a[72:75], v[80:83], v[40:43]
  ds_read_b64_tr_b16 a[26:27], v14 offset:51200
  ds_read_b64_tr_b16 a[28:29], v15 offset:49152
  ds_read_b64_tr_b16 a[30:31], v15 offset:51200
  v_mfma_f32_16x16x32_bf16 v[44:47], a[76:79], v[80:83], v[44:47]
  s_waitcnt lgkmcnt(14)
  ds_read_b64_tr_b16 a[32:33], v12 offset:53248
  v_mfma_f32_16x16x32_bf16 v[32:35], a[80:83], v[84:87], v[32:35]
  s_lshr_b32 s58, s2, 3
  s_mul_i32 s58, s58, 44032
  s_sub_u32 s59, 384, s28
  s_and_b32 s59, s59, 896
  s_add_u32 s58, s58, s59
  v_min_u32 v6, 42, v0
  v_lshlrev_b32 v6, 10, v6
  buffer_load_dword v7, v6, s[28:31], s58 offen
  v_mfma_f32_16x16x32_bf16 v[36:39], a[84:87], v[84:87], v[36:39]
  ds_read_b64_tr_b16 a[34:35], v12 offset:55296
  v_mfma_f32_16x16x32_bf16 v[40:43], a[88:91], v[84:87], v[40:43]
  ds_read_b64_tr_b16 a[36:37], v13 offset:53248
  v_mfma_f32_16x16x32_bf16 v[44:47], a[92:95], v[84:87], v[44:47]
  s_waitcnt lgkmcnt(14)
  ds_read_b64_tr_b16 a[38:39], v13 offset:55296
  v_mfma_f32_16x16x32_bf16 v[32:35], a[96:99], v[88:91], v[32:35]
  ds_read_b64_tr_b16 a[40:41], v14 offset:53248
  v_mfma_f32_16x16x32_bf16 v[36:39], a[100:103], v[88:91], v[36:39]
  ds_read_b64_tr_b16 a[42:43], v14 offset:55296
  ds_read_b64_tr_b16 a[44:45], v15 offset:53248
  ds_read_b64_tr_b16 a[46:47], v15 offset:55296
  v_mfma_f32_16x16x32_bf16 v[40:43], a[104:107], v[88:91], v[40:43]
  ds_read_b64_tr_b16 a[48:49], v12 offset:57344
  v_mfma_f32_16x16x32_bf16 v[44:47], a[108:111], v[88:91], v[44:47]
  s_waitcnt lgkmcnt(14)
  ds_read_b64_tr_b16 a[50:51], v12 offset:59392
  v_mfma_f32_16x16x32_bf16 v[32:35], a[112:115], v[92:95], v[32:35]
  ds_read_b64_tr_b16 v[196:197], v25 offset:0
  v_mfma_f32_16x16x32_bf16 v[36:39], a[116:119], v[92:95], v[36:39]
  s_waitcnt vmcnt(8)
  v_max3_u32 v48, v97, v101, v105
  v_max_u32 v48, v48, v109
  v_mfma_f32_16x16x32_bf16 v[40:43], a[120:123], v[92:95], v[40:43]
  ds_read_b64_tr_b16 a[52:53], v13 offset:57344
  ds_read_b64_tr_b16 v[198:199], v25 offset:1536
  v_mfma_f32_16x16x32_bf16 v[44:47], a[124:127], v[92:95], v[44:47]
  s_waitcnt lgkmcnt(14)
  ds_read_b64_tr_b16 a[54:55], v13 offset:59392
  ds_read_b64_tr_b16 a[56:57], v14 offset:57344
  v_cmp_eq_u32 vcc, -1, v48
  s_cbranch_vccnz Lretry25
Lcont26:
  v_mfma_f32_16x16x32_bf16 v[32:35], a[128:131], v[96:99], v[32:35]
  ds_read_b64_tr_b16 a[58:59], v14 offset:59392
  ds_read_b64_tr_b16 a[60:61], v15 offset:57344
  ds_read_b64_tr_b16 a[62:63], v15 offset:59392
  v_mfma_f32_16x16x32_bf16 v[36:39], a[132:135], v[96:99], v[36:39]
  ds_read_b64_tr_b16 v[200:201], v25 offset:32
  ds_read_b64_tr_b16 v[202:203], v25 offset:1568
  v_mfma_f32_16x16x32_bf16 v[40:43], a[136:139], v[96:99], v[40:43]
  ds_read_b64_tr_b16 v[204:205], v25 offset:64
  ds_read_b64_tr_b16 a[64:65], v12 offset:61440
  v_mfma_f32_16x16x32_bf16 v[44:47], a[140:143], v[96:99], v[44:47]
  s_waitcnt lgkmcnt(14)
  ds_read_b64_tr_b16 v[206:207], v25 offset:1600
  ds_read_b64_tr_b16 a[66:67], v12 offset:63488
  v_mfma_f32_16x16x32_bf16 v[32:35], a[144:147], v[100:103], v[32:35]
  ds_read_b64_tr_b16 v[208:209], v25 offset:3072
  ds_read_b64_tr_b16 a[68:69], v13 offset:61440
  v_mfma_f32_16x16x32_bf16 v[36:39], a[148:151], v[100:103], v[36:39]
  ds_read_b64_tr_b16 v[210:211], v25 offset:4608
  ds_read_b64_tr_b16 a[70:71], v13 offset:63488
  v_mfma_f32_16x16x32_bf16 v[40:43], a[152:155], v[100:103], v[40:43]
Lpage4:
  s_cbranch_execz Lback4
  ds_read_b64_tr_b16 v[212:213], v25 offset:3104
  ds_read_b64_tr_b16 a[72:73], v14 offset:61440
  v_mfma_f32_16x16x32_bf16 v[44:47], a[156:159], v[100:103], v[44:47]
  s_waitcnt lgkmcnt(14)
  ds_read_b64_tr_b16 a[74:75], v14 offset:63488
  ds_read_b64_tr_b16 a[76:77], v15 offset:61440
  ds_read_b64_tr_b16 a[78:79], v15 offset:63488
  ds_read_b64_tr_b16 v[214:215], v25 offset:4640
  ds_read_b64_tr_b16 v[216:217], v25 offset:3136
  ds_read_b64_tr_b16 v[218:219], v25 offset:4672
  v_mfma_f32_16x16x32_bf16 v[32:35], a[160:163], v[104:107], v[32:35]
  v_mfma_f32_16x16x32_bf16 v[36:39], a[164:167], v[104:107], v[36:39]
  v_mfma_f32_16x16x32_bf16 v[40:43], a[168:171], v[104:107], v[40:43]
  v_mfma_f32_16x16x32_bf16 v[44:47], a[172:175], v[104:107], v[44:47]
  s_waitcnt lgkmcnt(14)
  v_mfma_f32_16x16x32_bf16 v[32:35], a[0:3], v[108:111], v[32:35]
  s_waitcnt vmcnt(6)
  v_max_u32 v48, v113, v117
  v_mfma_f32_16x16x32_bf16 v[36:39], a[4:7], v[108:111], v[36:39]
  v_cmp_eq_u32 vcc, -1, v48
  v_mfma_f32_16x16x32_bf16 v[40:43], a[8:11], v[108:111], v[40:43]
  v_mfma_f32_16x16x32_bf16 v[44:47], a[12:15], v[108:111], v[44:47]
  s_waitcnt lgkmcnt(14)
  s_cbranch_vccnz Lretry27
Lcont28:
  v_mfma_f32_16x16x32_bf16 v[32:35], a[16:19], v[112:115], v[32:35]
  s_add_u32 s66, s64, 528384
  v_mfma_f32_16x16x32_bf16 v[36:39], a[20:23], v[112:115], v[36:39]
  v_mfma_f32_16x16x32_bf16 v[40:43], a[24:27], v[112:115], v[40:43]
  v_mfma_f32_16x16x32_bf16 v[44:47], a[28:31], v[112:115], v[44:47]
  s_waitcnt lgkmcnt(14)
  s_add_u32 s67, s66, s71
  v_mfma_f32_16x16x32_bf16 v[32:35], a[32:35], v[116:119], v[32:35]
  s_waitcnt vmcnt(4)
  v_max_u32 v48, v121, v125
  v_mfma_f32_16x16x32_bf16 v[36:39], a[36:39], v[116:119], v[36:39]
  v_cmp_eq_u32 vcc, -1, v48
  v_mfma_f32_16x16x32_bf16 v[40:43], a[40:43], v[116:119], v[40:43]
  s_add_u32 s68, s67, 33024
  v_mfma_f32_16x16x32_bf16 v[44:47], a[44:47], v[116:119], v[44:47]
  s_waitcnt lgkmcnt(14)
  s_cbranch_vccnz Lretry29
Lcont30:
  v_mfma_f32_16x16x32_bf16 v[32:35], a[48:51], v[120:123], v[32:35]
  v_mfma_f32_16x16x32_bf16 v[36:39], a[52:55], v[120:123], v[36:39]
  s_lshl_b32 s69, s6, 8
  v_mfma_f32_16x16x32_bf16 v[40:43], a[56:59], v[120:123], v[40:43]
  v_mfma_f32_16x16x32_bf16 v[44:47], a[60:63], v[120:123], v[44:47]
  s_waitcnt lgkmcnt(3)
  v_mfma_f32_16x16x32_bf16 v[32:35], a[64:67], v[124:127], v[32:35]
  s_add_u32 s69, s69, 65536
  v_mfma_f32_16x16x32_bf16 v[36:39], a[68:71], v[124:127], v[36:39]
  v_mfma_f32_16x16x32_bf16 v[40:43], a[72:75], v[124:127], v[40:43]
  v_mfma_f32_16x16x32_bf16 v[44:47], a[76:79], v[124:127], v[44:47]
  s_nop 3
  v_cvt_pk_bf16_f32 v48, v32, v33
  v_cvt_pk_bf16_f32 v49, v34, v35
  v_cvt_pk_bf16_f32 v50, v36, v37
  v_cvt_pk_bf16_f32 v51, v38, v39
  buffer_store_dwordx4 v[48:51], v16, s[8:11], s67 offen sc1
  v_cvt_pk_bf16_f32 v52, v40, v41
  v_cvt_pk_bf16_f32 v53, v42, v43
  v_cvt_pk_bf16_f32 v54, v44, v45
  v_cvt_pk_bf16_f32 v55, v46, v47
  buffer_store_dwordx4 v[52:55], v16, s[8:11], s68 offen sc1
  v_pk_add_f32 v[56:57], v[32:33], v[34:35]
  v_pk_mul_f32 v[58:59], v[32:33], v[32:33]
  v_pk_fma_f32 v[58:59], v[34:35], v[34:35], v[58:59]
  v_pk_add_f32 v[56:57], v[56:57], v[36:37]
  v_pk_fma_f32 v[58:59], v[36:37], v[36:37], v[58:59]
  v_pk_add_f32 v[56:57], v[56:57], v[38:39]
  v_pk_fma_f32 v[58:59], v[38:39], v[38:39], v[58:59]
  v_pk_add_f32 v[56:57], v[56:57], v[40:41]
  v_pk_fma_f32 v[58:59], v[40:41], v[40:41], v[58:59]
  v_pk_add_f32 v[56:57], v[56:57], v[42:43]
  v_pk_fma_f32 v[58:59], v[42:43], v[42:43], v[58:59]
  v_pk_add_f32 v[56:57], v[56:57], v[44:45]
  v_pk_fma_f32 v[58:59], v[44:45], v[44:45], v[58:59]
  v_pk_add_f32 v[56:57], v[56:57], v[46:47]
  v_pk_fma_f32 v[58:59], v[46:47], v[46:47], v[58:59]
  v_add_f32 v56, v56, v57
  v_add_f32 v57, v58, v59
  s_nop 1
  v_permlane32_swap_b32 v56, v57
  s_nop 0
  v_add_f32 v56, v56, v57
  v_mov_b32 v57, v56
  s_nop 1
  v_permlane16_swap_b32 v56, v57
  s_nop 0
  v_add_f32 v56, v56, v57
  v_mov_b32 v57, v56
  v_mov_b32 v58, s7
  v_mov_b32 v59, s7
  v_permlane32_swap_b32 v56, v57
  s_mov_b64 exec, 0xffff
  buffer_store_dwordx4 v[56:59], v18, s[8:11], s69 offen sc1
  s_mov_b64 exec, -1
  s_waitcnt lgkmcnt(0)
  s_barrier
  v_lshrrev_b32 v30, 3, v1
  s_waitcnt vmcnt(4)
  ds_read_b64_tr_b16 v[220:221], v25 offset:6144
  v_mul_u32_u24 v30, 1024, v30
  v_and_b32 v31, 7, v1
  ds_read_b64_tr_b16 v[222:223], v25 offset:7680
  v_and_b32 v26, 1, v21
  v_lshlrev_b32 v26, 1, v26
  ds_read_b64_tr_b16 v[224:225], v25 offset:6176
  v_xor_b32 v31, v31, v26
  v_lshl_add_u32 v26, v31, 4, v30
  v_xor_b32 v30, 64, v26
  ds_read_b64_tr_b16 v[226:227], v25 offset:7712
  v_add_u32 v27, 7168, v30
  v_add_u32 v28, 14336, v26
  ds_read_b64_tr_b16 v[228:229], v25 offset:6208
  v_add_u32 v29, 21504, v30
  v_lshl_add_u32 v31, v20, 4, v2
  v_add_u32 v4, 32000, v31
  ds_read_b64_tr_b16 v[230:231], v25 offset:7744
  v_add_u32 v8, 64000, v31
  v_add_u32 v9, 96000, v31
  v_lshlrev_b32 v2, 4, v20
  v_lshl_add_u32 v2, v21, 10, v2
  s_xor_b32 s65, s3, 0
  s_mul_i32 s65, s65, 132096
  s_add_u32 s65, s65, s66
  s_lshl_b32 s64, s3, 12
  s_add_u32 s67, s64, 0
  v_add_u32 v16, s67, v3
  v_lshl_add_u32 v18, v21, 9, v18
  v_lshrrev_b32 v17, 1, v21
  v_lshlrev_b32 v17, 10, v17
  v_and_b32 v30, 1, v21
  s_add_u32 m0, s60, 9216
  s_add_u32 s63, s76, 1232896
  buffer_load_dwordx4 v22, s[24:27], s63 offen lds
  v_lshl_add_u32 v17, v30, 11, v17
  v_lshl_add_u32 v17, v20, 4, v17
  s_mul_i32 s67, s6, 11
  s_min_u32 s67, s67, 76
  s_mul_i32 s68, s3, 3
  s_add_u32 s67, s67, s68
  s_lshl_b32 s67, s67, 11
  s_mul_i32 s69, s5, 176128
  s_add_u32 s67, s67, s69
  s_add_u32 s67, s67, 9437184
  s_cmp_lt_u32 s6, 6
  s_cselect_b32 s69, 11, 10
  s_sub_u32 s68, s69, s68
  s_lshl_b32 s69, s3, 8
  s_add_u32 s69, s69, 162816
  buffer_load_dwordx4 v23, s[24:27], s63 offen offset:1024 lds
  v_lshl_add_u32 v5, v20, 4, s69
  s_mov_b32 s69, 65536
  s_mul_i32 s72, s3, 20480
  s_add_u32 s72, s72, 65536
  v_lshl_add_u32 v30, v21, 9, s72
  v_add_u32 v12, v30, v12
  v_add_u32 v13, v30, v13
  v_add_u32 v14, v30, v14
  v_add_u32 v15, v30, v15
  v_lshlrev_b32 v10, 4, v20
  v_add_u32 v10, 162816, v10
  s_lshl_b32 s78, s5, 10
  s_add_u32 s78, s78, 32768
  s_lshl_b32 s79, s6, 7
  s_add_u32 s79, s79, s78
  buffer_load_dwordx4 v24, s[24:27], s63 offen offset:2048 lds
  v_mov_b32 v11, s7
  v_mov_b32 v84, 0x3f803f80
  v_mov_b32 v85, 0x3f803f80
  v_mov_b32 v86, 0x3f803f80
  v_mov_b32 v87, 0x3f803f80
  v_lshlrev_b32 v32, 16, v48
  v_and_b32 v33, s73, v48
  v_lshlrev_b32 v60, 16, v136
  v_and_b32 v61, s73, v136
  v_pk_add_f32 v[32:33], v[32:33], v[60:61]
  v_lshlrev_b32 v34, 16, v49
  v_and_b32 v35, s73, v49
  v_lshlrev_b32 v60, 16, v137
  v_and_b32 v61, s73, v137
  s_add_u32 m0, s60, 12288
  s_add_u32 s63, s76, 1320960
  buffer_load_dwordx4 v22, s[24:27], s63 offen lds
  v_pk_add_f32 v[34:35], v[34:35], v[60:61]
  v_lshlrev_b32 v36, 16, v50
  v_and_b32 v37, s73, v50
  v_lshlrev_b32 v60, 16, v138
  v_and_b32 v61, s73, v138
  v_pk_add_f32 v[36:37], v[36:37], v[60:61]
  v_lshlrev_b32 v38, 16, v51
  v_and_b32 v39, s73, v51
  v_lshlrev_b32 v60, 16, v139
  v_and_b32 v61, s73, v139
  v_pk_add_f32 v[38:39], v[38:39], v[60:61]
  v_lshlrev_b32 v40, 16, v52
  v_and_b32 v41, s73, v52
  v_lshlrev_b32 v60, 16, v140
  v_and_b32 v61, s73, v140
  buffer_load_dwordx4 v23, s[24:27], s63 offen offset:1024 lds
  v_pk_add_f32 v[40:41], v[40:41], v[60:61]
  v_lshlrev_b32 v42, 16, v53
  v_and_b32 v43, s73, v53
  v_lshlrev_b32 v60, 16, v141
  v_and_b32 v61, s73, v141
  v_pk_add_f32 v[42:43], v[42:43], v[60:61]
  v_lshlrev_b32 v44, 16, v54
  v_and_b32 v45, s73, v54
  v_lshlrev_b32 v60, 16, v142
  v_and_b32 v61, s73, v142
  v_pk_add_f32 v[44:45], v[44:45], v[60:61]
  v_lshlrev_b32 v46, 16, v55
  v_and_b32 v47, s73, v55
  v_lshlrev_b32 v60, 16, v143
  buffer_load_dwordx4 v24, s[24:27], s63 offen offset:2048 lds
  v_and_b32 v61, s73, v143
  v_pk_add_f32 v[46:47], v[46:47], v[60:61]
  v_mfma_f32_16x16x32_bf16 v[48:51], a[176:179], v[84:87], 0
  v_mfma_f32_16x16x32_bf16 v[52:55], a[180:183], v[84:87], 0
  v_mfma_f32_16x16x32_bf16 v[56:59], a[184:187], v[84:87], 0
  v_mfma_f32_16x16x32_bf16 v[48:51], a[188:191], v[84:87], v[48:51]
  v_mfma_f32_16x16x32_bf16 v[52:55], a[192:195], v[84:87], v[52:55]
  v_mfma_f32_16x16x32_bf16 v[56:59], a[196:199], v[84:87], v[56:59]
  v_mfma_f32_16x16x32_bf16 v[48:51], a[200:203], v[84:87], v[48:51]
  v_mfma_f32_16x16x32_bf16 v[52:55], a[204:207], v[84:87], v[52:55]
  v_mfma_f32_16x16x32_bf16 v[56:59], a[208:211], v[84:87], v[56:59]
  v_mfma_f32_16x16x32_bf16 v[48:51], a[212:215], v[84:87], v[48:51]
  v_mfma_f32_16x16x32_bf16 v[52:55], a[216:219], v[84:87], v[52:55]
  v_mfma_f32_16x16x32_bf16 v[56:59], a[220:223], v[84:87], v[56:59]
  v_mfma_f32_16x16x32_bf16 v[48:51], a[224:227], v[84:87], v[48:51]
  v_mfma_f32_16x16x32_bf16 v[52:55], a[228:231], v[84:87], v[52:55]
  v_mfma_f32_16x16x32_bf16 v[56:59], a[232:235], v[84:87], v[56:59]
  v_mfma_f32_16x16x32_bf16 v[48:51], a[236:239], v[84:87], v[48:51]
  v_mfma_f32_16x16x32_bf16 v[52:55], a[240:243], v[84:87], v[52:55]
  v_mfma_f32_16x16x32_bf16 v[56:59], a[244:247], v[84:87], v[56:59]
  v_mfma_f32_16x16x32_bf16 v[48:51], a[248:251], v[84:87], v[48:51]
  v_mfma_f32_16x16x32_bf16 v[52:55], a[252:255], v[84:87], v[52:55]
  v_mfma_f32_16x16x32_bf16 v[56:59], v[144:147], v[84:87], v[56:59]
  v_mfma_f32_16x16x32_bf16 v[48:51], v[148:151], v[84:87], v[48:51]
  v_mfma_f32_16x16x32_bf16 v[52:55], v[152:155], v[84:87], v[52:55]
  v_mfma_f32_16x16x32_bf16 v[56:59], v[156:159], v[84:87], v[56:59]
  s_waitcnt vmcnt(6)
  v_mfma_f32_16x16x32_bf16 v[48:51], v[160:163], v[84:87], v[48:51]
  s_add_u32 m0, s64, 0
  s_add_u32 s66, s65, 0
  buffer_load_dwordx4 v31, s[8:11], s66 offen offset:0 sc1 lds
  v_mfma_f32_16x16x32_bf16 v[52:55], v[164:167], v[84:87], v[52:55]
  buffer_load_dwordx4 v4, s[8:11], s66 offen offset:1024 sc1 lds
  v_mfma_f32_16x16x32_bf16 v[56:59], v[168:171], v[84:87], v[56:59]
  v_mfma_f32_16x16x32_bf16 v[48:51], v[172:175], v[84:87], v[48:51]
  buffer_load_dwordx4 v8, s[8:11], s66 offen offset:2048 sc1 lds
  v_mfma_f32_16x16x32_bf16 v[52:55], v[176:179], v[84:87], v[52:55]
  v_mfma_f32_16x16x32_bf16 v[56:59], v[180:183], v[84:87], v[56:59]
  buffer_load_dwordx4 v9, s[8:11], s66 offen offset:3072 sc1 lds
  v_mfma_f32_16x16x32_bf16 v[48:51], v[184:187], v[84:87], v[48:51]
  v_mfma_f32_16x16x32_bf16 v[52:55], v[188:191], v[84:87], v[52:55]
  buffer_load_dwordx4 v[116:119], v18, s[8:11], s69 offen offset:0 sc1
  v_mfma_f32_16x16x32_bf16 v[56:59], v[192:195], v[84:87], v[56:59]
  v_mfma_f32_16x16x32_bf16 v[48:51], v[196:199], v[84:87], v[48:51]
  buffer_load_dwordx4 v[120:123], v18, s[8:11], s69 offen offset:256 sc1
  v_mfma_f32_16x16x32_bf16 v[52:55], v[200:203], v[84:87], v[52:55]
  s_add_u32 m0, s64, 16384
  s_add_u32 s66, s65, 256
  buffer_load_dwordx4 v31, s[8:11], s66 offen offset:0 sc1 lds
  v_mfma_f32_16x16x32_bf16 v[56:59], v[204:207], v[84:87], v[56:59]
  v_mfma_f32_16x16x32_bf16 v[48:51], v[208:211], v[84:87], v[48:51]
  buffer_load_dwordx4 v4, s[8:11], s66 offen offset:1024 sc1 lds
  v_mfma_f32_16x16x32_bf16 v[52:55], v[212:215], v[84:87], v[52:55]
  v_mfma_f32_16x16x32_bf16 v[56:59], v[216:219], v[84:87], v[56:59]
  s_waitcnt lgkmcnt(0)
  buffer_load_dwordx4 v8, s[8:11], s66 offen offset:2048 sc1 lds
  v_mfma_f32_16x16x32_bf16 v[48:51], v[220:223], v[84:87], v[48:51]
  v_mfma_f32_16x16x32_bf16 v[52:55], v[224:227], v[84:87], v[52:55]
  buffer_load_dwordx4 v9, s[8:11], s66 offen offset:3072 sc1 lds
  v_mfma_f32_16x16x32_bf16 v[56:59], v[228:231], v[84:87], v[56:59]
  s_waitcnt vmcnt(13)
  ds_read_b64_tr_b16 v[232:233], v25 offset:9216
  ds_read_b64_tr_b16 v[234:235], v25 offset:10752
  ds_read_b64_tr_b16 v[236:237], v25 offset:9248
  ds_read_b64_tr_b16 v[238:239], v25 offset:10784
  ds_read_b64_tr_b16 v[240:241], v25 offset:9280
  ds_read_b64_tr_b16 v[242:243], v25 offset:10816
  s_waitcnt vmcnt(10)
  ds_read_b64_tr_b16 v[244:245], v25 offset:12288
  ds_read_b64_tr_b16 v[246:247], v25 offset:13824
  ds_read_b64_tr_b16 v[248:249], v25 offset:12320
  ds_read_b64_tr_b16 v[250:251], v25 offset:13856
  ds_read_b64_tr_b16 v[252:253], v25 offset:12352
  ds_read_b64_tr_b16 v[254:255], v25 offset:13888
  s_waitcnt lgkmcnt(6)
  v_mfma_f32_16x16x32_bf16 v[48:51], v[232:235], v[84:87], v[48:51]
  v_mfma_f32_16x16x32_bf16 v[52:55], v[236:239], v[84:87], v[52:55]
  v_mfma_f32_16x16x32_bf16 v[56:59], v[240:243], v[84:87], v[56:59]
  s_waitcnt lgkmcnt(0)
  v_mfma_f32_16x16x32_bf16 v[48:51], v[244:247], v[84:87], v[48:51]
  v_mfma_f32_16x16x32_bf16 v[52:55], v[248:251], v[84:87], v[52:55]
  v_mfma_f32_16x16x32_bf16 v[56:59], v[252:255], v[84:87], v[56:59]
  s_mul_i32 s62, s3, 360448
  s_lshl_b32 s63, s6, 7
  s_add_u32 s61, s63, 1376256
  s_add_u32 s62, s62, s63
  s_lshl_b32 s76, s81, 2
  s_and_b32 s77, s6, 0
  s_xor_b32 s76, s76, s77
  s_lshl_b32 s77, s76, 12
  s_lshl_b32 s76, s76, 15
  s_waitcnt vmcnt(6)
  ds_read_b64 v[100:101], v16 offset:0
  ds_read_b64 v[102:103], v16 offset:1024
  ds_read_b64 v[104:105], v16 offset:2048
  ds_read_b64 v[106:107], v16 offset:3072
  s_waitcnt lgkmcnt(0)
  v_max3_u32 v100, v101, v103, v105
  v_max_u32 v100, v100, v107
  v_cmp_eq_u32 vcc, -1, v100
  s_cbranch_vccnz Lretry33
Lcont34:
  s_barrier
  ds_read_b128 a[128:131], v3 offset:0
  ds_read_b128 a[132:135], v3 offset:1024
  ds_read_b128 a[136:139], v3 offset:2048
  ds_read_b128 a[140:143], v3 offset:3072
  ds_read_b128 a[144:147], v3 offset:4096
  s_waitcnt lgkmcnt(4)
  v_mfma_f32_16x16x32_bf16 v[60:63], a[176:179], a[128:131], 0
  s_add_u32 m0, s64, 32768
  s_add_u32 s66, s65, 512
  ds_read_b128 a[148:151], v3 offset:5120
  v_mfma_f32_16x16x32_bf16 v[64:67], a[180:183], a[128:131], 0
  buffer_load_dwordx4 v31, s[8:11], s66 offen offset:0 sc1 lds
  v_mfma_f32_16x16x32_bf16 v[68:71], a[184:187], a[128:131], 0
  s_waitcnt lgkmcnt(4)
  s_waitcnt vmcnt(5)
  v_xor_b32 v30, s7, v118
  v_mfma_f32_16x16x32_bf16 v[60:63], a[188:191], a[132:135], v[60:63]
  ds_read_b128 a[152:155], v3 offset:6144
  v_bitop3_b32 v30, v30, s7, v122 bitop3:0xf6
  v_mfma_f32_16x16x32_bf16 v[64:67], a[192:195], a[132:135], v[64:67]
  buffer_load_dwordx4 v4, s[8:11], s66 offen offset:1024 sc1 lds
  v_mfma_f32_16x16x32_bf16 v[68:71], a[196:199], a[132:135], v[68:71]
  s_waitcnt lgkmcnt(4)
  v_cmp_ne_u32 vcc, 0, v30
  v_mfma_f32_16x16x32_bf16 v[60:63], a[200:203], a[136:139], v[60:63]
  ds_read_b128 a[156:159], v3 offset:7168
  s_cbranch_vccnz Lretry31
Lcont32:
  v_add_f32 v116, v116, v120
  v_mfma_f32_16x16x32_bf16 v[64:67], a[204:207], a[136:139], v[64:67]
  buffer_load_dwordx4 v8, s[8:11], s66 offen offset:2048 sc1 lds
  v_mfma_f32_16x16x32_bf16 v[68:71], a[208:211], a[136:139], v[68:71]
  s_waitcnt lgkmcnt(4)
  v_add_f32 v117, v117, v121
  s_nop 1
  v_permlane32_swap_b32 v116, v117
  v_mfma_f32_16x16x32_bf16 v[60:63], a[212:215], a[140:143], v[60:63]
  ds_read_b128 a[128:131], v3 offset:8192
  v_add_f32 v116, v116, v117
  v_mfma_f32_16x16x32_bf16 v[64:67], a[216:219], a[140:143], v[64:67]
  buffer_load_dwordx4 v9, s[8:11], s66 offen offset:3072 sc1 lds
  s_add_u32 m0, s64, 49152
  v_mfma_f32_16x16x32_bf16 v[68:71], a[220:223], a[140:143], v[68:71]
  s_waitcnt lgkmcnt(4)
  s_add_u32 s66, s65, 768
  v_mov_b32 v117, v116
  v_mfma_f32_16x16x32_bf16 v[60:63], a[224:227], a[144:147], v[60:63]
  ds_read_b128 a[132:135], v3 offset:9216
  v_permlane16_swap_b32 v116, v117
  v_mfma_f32_16x16x32_bf16 v[64:67], a[228:231], a[144:147], v[64:67]
  buffer_load_dwordx4 v31, s[8:11], s66 offen offset:0 sc1 lds
  v_add_f32 v116, v116, v117
  v_mfma_f32_16x16x32_bf16 v[68:71], a[232:235], a[144:147], v[68:71]
  s_waitcnt lgkmcnt(4)
  v_mul_f32 v116, 0x3b000000, v116
  v_mov_b32 v117, v116
  v_mfma_f32_16x16x32_bf16 v[60:63], a[236:239], a[148:151], v[60:63]
  ds_read_b128 a[136:139], v3 offset:10240
  v_permlane32_swap_b32 v116, v117
  v_mfma_f32_16x16x32_bf16 v[64:67], a[240:243], a[148:151], v[64:67]
  buffer_load_dwordx4 v4, s[8:11], s66 offen offset:1024 sc1 lds
  v_mfma_f32_16x16x32_bf16 v[68:71], a[244:247], a[148:151], v[68:71]
  s_waitcnt lgkmcnt(4)
  v_fma_f32 v117, -v116, v116, v117
  v_max_f32 v117, 0, v117
  v_mfma_f32_16x16x32_bf16 v[60:63], a[248:251], a[152:155], v[60:63]
  ds_read_b128 a[140:143], v3 offset:11264
  v_add_f32 v117, 0x3727c5ac, v117
  v_mfma_f32_16x16x32_bf16 v[64:67], a[252:255], a[152:155], v[64:67]
  buffer_load_dwordx4 v8, s[8:11], s66 offen offset:2048 sc1 lds
  v_rsq_f32 v118, v117
  v_mfma_f32_16x16x32_bf16 v[68:71], v[144:147], a[152:155], v[68:71]
  s_waitcnt lgkmcnt(4)
  buffer_load_dwordx4 v9, s[8:11], s66 offen offset:3072 sc1 lds
  v_mul_f32 v119, v117, v118
  v_mfma_f32_16x16x32_bf16 v[60:63], v[148:151], a[156:159], v[60:63]
  ds_read_b128 a[144:147], v3 offset:12288
  s_waitcnt vmcnt(8)
  ds_read_b64 v[100:101], v16 offset:16384
  ds_read_b64 v[102:103], v16 offset:17408
  ds_read_b64 v[104:105], v16 offset:18432
  ds_read_b64 v[106:107], v16 offset:19456
  v_mul_f32 v117, s74, v118
  v_mul_f32 v120, v118, v118
  v_mul_f32 v118, s75, v118
  v_mul_f32 v118, v118, v120
  ds_write_b128 v5, v[116:119]
  v_mfma_f32_16x16x32_bf16 v[64:67], v[152:155], a[156:159], v[64:67]
  s_add_u32 m0, s72, 0
  s_xor_b32 s63, s76, 0
  v_mfma_f32_16x16x32_bf16 v[68:71], v[156:159], a[156:159], v[68:71]
  s_waitcnt lgkmcnt(9)
  s_add_u32 s63, s63, s62
  v_mfma_f32_16x16x32_bf16 v[60:63], v[160:163], a[128:131], v[60:63]
  ds_read_b128 a[148:151], v3 offset:13312
  v_mfma_f32_16x16x32_bf16 v[64:67], v[164:167], a[128:131], v[64:67]
  buffer_load_dwordx4 v26, s[28:31], s63 offen offset:0  lds
  v_mfma_f32_16x16x32_bf16 v[68:71], v[168:171], a[128:131], v[68:71]
  s_waitcnt lgkmcnt(9)
  s_waitcnt lgkmcnt(2)
  v_max3_u32 v100, v101, v103, v105
  v_mfma_f32_16x16x32_bf16 v[60:63], v[172:175], a[132:135], v[60:63]
  ds_read_b128 a[152:155], v3 offset:14336
  v_max_u32 v100, v100, v107
  v_mfma_f32_16x16x32_bf16 v[64:67], v[176:179], a[132:135], v[64:67]
  buffer_load_dwordx4 v27, s[28:31], s63 offen offset:1024  lds
  v_mfma_f32_16x16x32_bf16 v[68:71], v[180:183], a[132:135], v[68:71]
  v_cmp_eq_u32 vcc, -1, v100
  v_mfma_f32_16x16x32_bf16 v[60:63], v[184:187], a[136:139], v[60:63]
  ds_read_b128 a[156:159], v3 offset:15360
  v_mfma_f32_16x16x32_bf16 v[64:67], v[188:191], a[136:139], v[64:67]
  s_cbranch_vccnz Lretry35
Lcont36:
  s_waitcnt lgkmcnt(3)
  s_barrier
  ds_read_b128 v[136:139], v10 offset:0
  buffer_load_dwordx4 v28, s[28:31], s63 offen offset:2048  lds
  v_mfma_f32_16x16x32_bf16 v[68:71], v[192:195], a[136:139], v[68:71]
  v_and_b32 v24, 1, v21
  v_mfma_f32_16x16x32_bf16 v[60:63], v[196:199], a[140:143], v[60:63]
  ds_read_b128 a[128:131], v3 offset:16384
  v_bfrev_b32 v25, 1
  v_mfma_f32_16x16x32_bf16 v[64:67], v[200:203], a[140:143], v[64:67]
  buffer_load_dwordx4 v29, s[28:31], s63 offen offset:3072  lds
  s_add_u32 m0, s72, 4096
  v_mfma_f32_16x16x32_bf16 v[68:71], v[204:207], a[140:143], v[68:71]
  s_xor_b32 s63, s76, 32768
  s_add_u32 s63, s63, s62
  v_mfma_f32_16x16x32_bf16 v[60:63], v[208:211], a[144:147], v[60:63]
  ds_read_b128 a[132:135], v3 offset:17408
  v_mfma_f32_16x16x32_bf16 v[64:67], v[212:215], a[144:147], v[64:67]
  buffer_load_dwordx4 v26, s[28:31], s63 offen offset:0  lds
  v_mfma_f32_16x16x32_bf16 v[68:71], v[216:219], a[144:147], v[68:71]
  s_waitcnt lgkmcnt(5)
  v_cmp_gt_u32 vcc, s68, v24
  s_nop 1
  v_cndmask_b32 v22, v25, v17, vcc
  v_mfma_f32_16x16x32_bf16 v[60:63], v[220:223], a[148:151], v[60:63]
  ds_read_b128 a[136:139], v3 offset:18432
  v_lshl_add_u32 v24, v24, 3, 2
  v_mfma_f32_16x16x32_bf16 v[64:67], v[224:227], a[148:151], v[64:67]
  buffer_load_dwordx4 v27, s[28:31], s63 offen offset:1024  lds
  v_mfma_f32_16x16x32_bf16 v[68:71], v[228:231], a[148:151], v[68:71]
  s_waitcnt lgkmcnt(5)
  v_add_u32 v23, 4096, v17
  v_mfma_f32_16x16x32_bf16 v[60:63], v[232:235], a[152:155], v[60:63]
  ds_read_b128 a[140:143], v3 offset:19456
  v_mfma_f32_16x16x32_bf16 v[64:67], v[236:239], a[152:155], v[64:67]
  buffer_load_dwordx4 v28, s[28:31], s63 offen offset:2048  lds
  s_min_u32 s1, s68, 3
  v_cmp_gt_u32 vcc, s1, v24
  s_nop 1
  v_cndmask_b32 v23, v25, v23, vcc
  v_mfma_f32_16x16x32_bf16 v[68:71], v[240:243], a[152:155], v[68:71]
  s_waitcnt lgkmcnt(5)
  v_lshlrev_b32 v19, 2, v0
  v_mfma_f32_16x16x32_bf16 v[60:63], v[244:247], a[156:159], v[60:63]
  ds_read_b128 a[144:147], v3 offset:20480
  v_mfma_f32_16x16x32_bf16 v[64:67], v[248:251], a[156:159], v[64:67]
  buffer_load_dwordx4 v29, s[28:31], s63 offen offset:3072  lds
  v_cmp_gt_u32 vcc, 32, v0
  s_nop 1
  v_cndmask_b32 v19, v25, v19, vcc
  v_and_b32 v25, 7, v1
  v_lshlrev_b32 v25, 7, v25
  v_mfma_f32_16x16x32_bf16 v[68:71], v[252:255], a[156:159], v[68:71]
  s_waitcnt lgkmcnt(5)
.p2align 3
  v_pk_fma_f32 v[60:61], v[48:49], v[136:137], v[60:61] op_sel_hi:[1,0,1] neg_lo:[0,1,0] neg_hi:[0,1,0]
  v_pk_fma_f32 v[62:63], v[50:51], v[136:137], v[62:63] op_sel_hi:[1,0,1] neg_lo:[0,1,0] neg_hi:[0,1,0]
  v_pk_fma_f32 v[64:65], v[52:53], v[136:137], v[64:65] op_sel_hi:[1,0,1] neg_lo:[0,1,0] neg_hi:[0,1,0]
  v_pk_fma_f32 v[66:67], v[54:55], v[136:137], v[66:67] op_sel_hi:[1,0,1] neg_lo:[0,1,0] neg_hi:[0,1,0]
  s_nop 2
  v_pk_fma_f32 v[68:69], v[56:57], v[136:137], v[68:69] op_sel_hi:[1,0,1] neg_lo:[0,1,0] neg_hi:[0,1,0]
  v_pk_fma_f32 v[70:71], v[58:59], v[136:137], v[70:71] op_sel_hi:[1,0,1] neg_lo:[0,1,0] neg_hi:[0,1,0]
  v_pk_mul_f32 v[116:117], v[60:61], v[60:61]
  v_pk_mul_f32 v[118:119], v[62:63], v[62:63]
  v_pk_mul_f32 v[120:121], v[64:65], v[64:65]
  v_pk_mul_f32 v[122:123], v[66:67], v[66:67]
  v_pk_mul_f32 v[124:125], v[68:69], v[68:69]
  v_pk_mul_f32 v[126:127], v[70:71], v[70:71]
  v_pk_fma_f32 v[116:117], v[116:117], v[138:139], v[136:137] op_sel:[0,0,1] op_sel_hi:[1,0,1]
  v_pk_fma_f32 v[118:119], v[118:119], v[138:139], v[136:137] op_sel:[0,0,1] op_sel_hi:[1,0,1]
  v_pk_fma_f32 v[120:121], v[120:121], v[138:139], v[136:137] op_sel:[0,0,1] op_sel_hi:[1,0,1]
  v_pk_fma_f32 v[122:123], v[122:123], v[138:139], v[136:137] op_sel:[0,0,1] op_sel_hi:[1,0,1]
  v_pk_fma_f32 v[124:125], v[124:125], v[138:139], v[136:137] op_sel:[0,0,1] op_sel_hi:[1,0,1]
  v_pk_fma_f32 v[126:127], v[126:127], v[138:139], v[136:137] op_sel:[0,0,1] op_sel_hi:[1,0,1]
  v_pk_mul_f32 v[116:117], v[116:117], v[60:61]
  v_pk_mul_f32 v[118:119], v[118:119], v[62:63]
  v_pk_mul_f32 v[120:121], v[120:121], v[64:65]
  v_pk_mul_f32 v[122:123], v[122:123], v[66:67]
  v_pk_mul_f32 v[124:125], v[124:125], v[68:69]
  v_pk_mul_f32 v[126:127], v[126:127], v[70:71]
  s_waitcnt lgkmcnt(4)
  v_mfma_f32_16x16x32_bf16 v[72:75], a[176:179], a[128:131], 0
  s_add_u32 m0, s72, 8192
  s_xor_b32 s63, s76, 65536
  ds_read_b128 a[148:151], v3 offset:21504
  v_mfma_f32_16x16x32_bf16 v[76:79], a[180:183], a[128:131], 0
  s_add_u32 s63, s63, s62
  buffer_load_dwordx4 v26, s[28:31], s63 offen offset:0  lds
  v_mfma_f32_16x16x32_bf16 v[80:83], a[184:187], a[128:131], 0
  s_waitcnt lgkmcnt(4)
  v_exp_f32 v116, v116
  v_mfma_f32_16x16x32_bf16 v[72:75], a[188:191], a[132:135], v[72:75]
  ds_read_b128 a[152:155], v3 offset:22528
  v_mfma_f32_16x16x32_bf16 v[76:79], a[192:195], a[132:135], v[76:79]
  buffer_load_dwordx4 v27, s[28:31], s63 offen offset:1024  lds
  v_mfma_f32_16x16x32_bf16 v[80:83], a[196:199], a[132:135], v[80:83]
  s_waitcnt lgkmcnt(4)
  v_exp_f32 v117, v117
  v_mfma_f32_16x16x32_bf16 v[72:75], a[200:203], a[136:139], v[72:75]
  ds_read_b128 a[156:159], v3 offset:23552
  v_exp_f32 v118, v118
  v_mfma_f32_16x16x32_bf16 v[76:79], a[204:207], a[136:139], v[76:79]
  v_exp_f32 v119, v119
  v_mfma_f32_16x16x32_bf16 v[80:83], a[208:211], a[136:139], v[80:83]
  s_waitcnt lgkmcnt(4)
  buffer_load_dwordx4 v28, s[28:31], s63 offen offset:2048  lds
  v_mfma_f32_16x16x32_bf16 v[72:75], a[212:215], a[140:143], v[72:75]
  ds_read_b128 a[128:131], v3 offset:24576
  v_exp_f32 v120, v120
  v_mfma_f32_16x16x32_bf16 v[76:79], a[216:219], a[140:143], v[76:79]
  s_waitcnt vmcnt(15)
  ds_read_b64 v[100:101], v16 offset:32768
  v_exp_f32 v121, v121
  v_mfma_f32_16x16x32_bf16 v[80:83], a[220:223], a[140:143], v[80:83]
  s_waitcnt lgkmcnt(5)
  ds_read_b64 v[102:103], v16 offset:33792
  v_mfma_f32_16x16x32_bf16 v[72:75], a[224:227], a[144:147], v[72:75]
  ds_read_b128 a[132:135], v3 offset:25600
  ds_read_b64 v[104:105], v16 offset:34816
  ds_read_b64 v[106:107], v16 offset:35840
  v_exp_f32 v122, v122
  v_mfma_f32_16x16x32_bf16 v[76:79], a[228:231], a[144:147], v[76:79]
  buffer_load_dwordx4 v29, s[28:31], s63 offen offset:3072  lds
  s_add_u32 m0, s72, 12288
  v_exp_f32 v123, v123
  v_mfma_f32_16x16x32_bf16 v[80:83], a[232:235], a[144:147], v[80:83]
  s_waitcnt lgkmcnt(8)
  s_xor_b32 s63, s76, 98304
  v_mfma_f32_16x16x32_bf16 v[72:75], a[236:239], a[148:151], v[72:75]
  s_add_u32 s63, s63, s62
  ds_read_b128 a[136:139], v3 offset:26624
  v_exp_f32 v124, v124
  v_mfma_f32_16x16x32_bf16 v[76:79], a[240:243], a[148:151], v[76:79]
  buffer_load_dwordx4 v26, s[28:31], s63 offen offset:0  lds
  v_exp_f32 v125, v125
  v_mfma_f32_16x16x32_bf16 v[80:83], a[244:247], a[148:151], v[80:83]
  s_waitcnt lgkmcnt(8)
  s_waitcnt lgkmcnt(1)
  v_max3_u32 v100, v101, v103, v105
  v_exp_f32 v126, v126
  v_exp_f32 v127, v127
  v_pk_fma_f32 v[116:117], v[116:117], v[138:139], v[138:139] op_sel:[0,1,1] op_sel_hi:[1,1,1]
  v_pk_fma_f32 v[118:119], v[118:119], v[138:139], v[138:139] op_sel:[0,1,1] op_sel_hi:[1,1,1]
  v_pk_fma_f32 v[120:121], v[120:121], v[138:139], v[138:139] op_sel:[0,1,1] op_sel_hi:[1,1,1]
  v_pk_fma_f32 v[122:123], v[122:123], v[138:139], v[138:139] op_sel:[0,1,1] op_sel_hi:[1,1,1]
  v_pk_fma_f32 v[124:125], v[124:125], v[138:139], v[138:139] op_sel:[0,1,1] op_sel_hi:[1,1,1]
  v_pk_fma_f32 v[126:127], v[126:127], v[138:139], v[138:139] op_sel:[0,1,1] op_sel_hi:[1,1,1]
  v_mfma_f32_16x16x32_bf16 v[72:75], a[248:251], a[152:155], v[72:75]
  ds_read_b128 a[140:143], v3 offset:27648
  v_mfma_f32_16x16x32_bf16 v[76:79], a[252:255], a[152:155], v[76:79]
  v_rcp_f32 v116, v116
  v_mfma_f32_16x16x32_bf16 v[80:83], v[144:147], a[152:155], v[80:83]
  buffer_load_dwordx4 v27, s[28:31], s63 offen offset:1024  lds
  v_mfma_f32_16x16x32_bf16 v[72:75], v[148:151], a[156:159], v[72:75]
  ds_read_b128 a[144:147], v3 offset:28672
  v_max_u32 v100, v100, v107
  v_mfma_f32_16x16x32_bf16 v[76:79], v[152:155], a[156:159], v[76:79]
  v_rcp_f32 v117, v117
  v_mfma_f32_16x16x32_bf16 v[80:83], v[156:159], a[156:159], v[80:83]
  v_rcp_f32 v118, v118
  v_mfma_f32_16x16x32_bf16 v[72:75], v[160:163], a[128:131], v[72:75]
  ds_read_b128 a[148:151], v3 offset:29696
  v_cmp_eq_u32 vcc, -1, v100
  v_mfma_f32_16x16x32_bf16 v[76:79], v[164:167], a[128:131], v[76:79]
  s_cbranch_vccnz Lretry37
Lcont38:
  s_barrier
  buffer_load_dwordx4 v28, s[28:31], s63 offen offset:2048  lds
  v_mfma_f32_16x16x32_bf16 v[80:83], v[168:171], a[128:131], v[80:83]
  v_rcp_f32 v119, v119
  v_mfma_f32_16x16x32_bf16 v[72:75], v[172:175], a[132:135], v[72:75]
  ds_read_b128 a[152:155], v3 offset:30720
  v_rcp_f32 v120, v120
  v_mfma_f32_16x16x32_bf16 v[76:79], v[176:179], a[132:135], v[76:79]
  buffer_load_dwordx4 v29, s[28:31], s63 offen offset:3072  lds
  v_rcp_f32 v121, v121
  v_mfma_f32_16x16x32_bf16 v[80:83], v[180:183], a[132:135], v[80:83]
  s_waitcnt lgkmcnt(4)
  s_add_u32 m0, s72, 16384
  v_mfma_f32_16x16x32_bf16 v[72:75], v[184:187], a[136:139], v[72:75]
  s_xor_b32 s63, s76, 131072
  ds_read_b128 a[156:159], v3 offset:31744
  v_rcp_f32 v122, v122
  v_mfma_f32_16x16x32_bf16 v[76:79], v[188:191], a[136:139], v[76:79]
  ds_read_b128 v[140:143], v10 offset:256
  s_add_u32 s63, s63, s62
  v_rcp_f32 v123, v123
  v_mfma_f32_16x16x32_bf16 v[80:83], v[192:195], a[136:139], v[80:83]
  s_waitcnt lgkmcnt(5)
  buffer_load_dwordx4 v26, s[28:31], s63 offen offset:0  lds
  v_mfma_f32_16x16x32_bf16 v[72:75], v[196:199], a[140:143], v[72:75]
  ds_read_b128 a[128:131], v3 offset:32768
  v_rcp_f32 v124, v124
  v_mfma_f32_16x16x32_bf16 v[76:79], v[200:203], a[140:143], v[76:79]
  v_rcp_f32 v125, v125
  v_mfma_f32_16x16x32_bf16 v[80:83], v[204:207], a[140:143], v[80:83]
  s_waitcnt lgkmcnt(5)
Lpage5:
  s_cbranch_execz Lback5
  v_rcp_f32 v126, v126
  v_rcp_f32 v127, v127
  v_pk_mul_f32 v[116:117], v[116:117], v[60:61]
  v_pk_mul_f32 v[118:119], v[118:119], v[62:63]
  v_pk_mul_f32 v[120:121], v[120:121], v[64:65]
  v_pk_mul_f32 v[122:123], v[122:123], v[66:67]
  v_pk_mul_f32 v[124:125], v[124:125], v[68:69]
  v_pk_mul_f32 v[126:127], v[126:127], v[70:71]
  v_mfma_f32_16x16x32_bf16 v[72:75], v[208:211], a[144:147], v[72:75]
  ds_read_b128 a[132:135], v3 offset:33792
  v_cvt_pk_bf16_f32 v128, v116, v117
  v_mfma_f32_16x16x32_bf16 v[76:79], v[212:215], a[144:147], v[76:79]
  buffer_load_dwordx4 v27, s[28:31], s63 offen offset:1024  lds
  v_mfma_f32_16x16x32_bf16 v[80:83], v[216:219], a[144:147], v[80:83]
  s_waitcnt lgkmcnt(5)
  v_cvt_pk_bf16_f32 v129, v118, v119
  v_cvt_pk_bf16_f32 v130, v120, v121
  v_mfma_f32_16x16x32_bf16 v[72:75], v[220:223], a[148:151], v[72:75]
  ds_read_b128 a[136:139], v3 offset:34816
  v_cvt_pk_bf16_f32 v131, v122, v123
  v_mfma_f32_16x16x32_bf16 v[76:79], v[224:227], a[148:151], v[76:79]
  buffer_load_dwordx4 v28, s[28:31], s63 offen offset:2048  lds
  v_mfma_f32_16x16x32_bf16 v[80:83], v[228:231], a[148:151], v[80:83]
  s_waitcnt lgkmcnt(5)
  v_cvt_pk_bf16_f32 v132, v124, v125
  v_cvt_pk_bf16_f32 v133, v126, v127
  v_mfma_f32_16x16x32_bf16 v[72:75], v[232:235], a[152:155], v[72:75]
  ds_read_b128 a[140:143], v3 offset:35840
  v_permlane16_swap_b32 v128, v130
  v_mfma_f32_16x16x32_bf16 v[76:79], v[236:239], a[152:155], v[76:79]
  v_permlane16_swap_b32 v129, v131
  v_permlane16_swap_b32 v132, v134
  v_mfma_f32_16x16x32_bf16 v[80:83], v[240:243], a[152:155], v[80:83]
  s_waitcnt lgkmcnt(5)
  buffer_load_dwordx4 v29, s[28:31], s63 offen offset:3072  lds
  v_permlane16_swap_b32 v133, v135
  v_mfma_f32_16x16x32_bf16 v[72:75], v[244:247], a[156:159], v[72:75]
  ds_read_b128 a[144:147], v3 offset:36864
  buffer_store_dwordx4 v[128:131], v22, s[8:11], s67 offen offset:0 sc1
  buffer_store_dwordx4 v[132:135], v23, s[8:11], s67 offen offset:0 sc1
  v_mfma_f32_16x16x32_bf16 v[76:79], v[248:251], a[156:159], v[76:79]
  v_mfma_f32_16x16x32_bf16 v[80:83], v[252:255], a[156:159], v[80:83]
  s_waitcnt lgkmcnt(5)
.p2align 3
  s_nop 1
  v_pk_fma_f32 v[72:73], v[48:49], v[140:141], v[72:73] op_sel_hi:[1,0,1] neg_lo:[0,1,0] neg_hi:[0,1,0]
  v_pk_fma_f32 v[74:75], v[50:51], v[140:141], v[74:75] op_sel_hi:[1,0,1] neg_lo:[0,1,0] neg_hi:[0,1,0]
  s_nop 1
  v_pk_fma_f32 v[76:77], v[52:53], v[140:141], v[76:77] op_sel_hi:[1,0,1] neg_lo:[0,1,0] neg_hi:[0,1,0]
  v_pk_fma_f32 v[78:79], v[54:55], v[140:141], v[78:79] op_sel_hi:[1,0,1] neg_lo:[0,1,0] neg_hi:[0,1,0]
  v_pk_fma_f32 v[80:81], v[56:57], v[140:141], v[80:81] op_sel_hi:[1,0,1] neg_lo:[0,1,0] neg_hi:[0,1,0]
  v_pk_fma_f32 v[82:83], v[58:59], v[140:141], v[82:83] op_sel_hi:[1,0,1] neg_lo:[0,1,0] neg_hi:[0,1,0]
  v_pk_mul_f32 v[116:117], v[72:73], v[72:73]
  v_pk_mul_f32 v[118:119], v[74:75], v[74:75]
  v_pk_mul_f32 v[120:121], v[76:77], v[76:77]
  v_pk_mul_f32 v[122:123], v[78:79], v[78:79]
  v_pk_mul_f32 v[124:125], v[80:81], v[80:81]
  v_pk_mul_f32 v[126:127], v[82:83], v[82:83]
  v_pk_fma_f32 v[116:117], v[116:117], v[142:143], v[140:141] op_sel:[0,0,1] op_sel_hi:[1,0,1]
  v_pk_fma_f32 v[118:119], v[118:119], v[142:143], v[140:141] op_sel:[0,0,1] op_sel_hi:[1,0,1]
  v_pk_fma_f32 v[120:121], v[120:121], v[142:143], v[140:141] op_sel:[0,0,1] op_sel_hi:[1,0,1]
  v_pk_fma_f32 v[122:123], v[122:123], v[142:143], v[140:141] op_sel:[0,0,1] op_sel_hi:[1,0,1]
  v_pk_fma_f32 v[124:125], v[124:125], v[142:143], v[140:141] op_sel:[0,0,1] op_sel_hi:[1,0,1]
  v_pk_fma_f32 v[126:127], v[126:127], v[142:143], v[140:141] op_sel:[0,0,1] op_sel_hi:[1,0,1]
  v_pk_mul_f32 v[116:117], v[116:117], v[72:73]
  v_pk_mul_f32 v[118:119], v[118:119], v[74:75]
  v_pk_mul_f32 v[120:121], v[120:121], v[76:77]
  v_pk_mul_f32 v[122:123], v[122:123], v[78:79]
  v_pk_mul_f32 v[124:125], v[124:125], v[80:81]
  v_pk_mul_f32 v[126:127], v[126:127], v[82:83]
  v_exp_f32 v116, v116
  v_exp_f32 v117, v117
  v_exp_f32 v118, v118
  v_exp_f32 v119, v119
  v_exp_f32 v120, v120
  v_exp_f32 v121, v121
  v_exp_f32 v122, v122
  v_exp_f32 v123, v123
  v_exp_f32 v124, v124
  v_exp_f32 v125, v125
  v_exp_f32 v126, v126
  v_exp_f32 v127, v127
  v_pk_fma_f32 v[116:117], v[116:117], v[142:143], v[142:143] op_sel:[0,1,1] op_sel_hi:[1,1,1]
  v_pk_fma_f32 v[118:119], v[118:119], v[142:143], v[142:143] op_sel:[0,1,1] op_sel_hi:[1,1,1]
  v_pk_fma_f32 v[120:121], v[120:121], v[142:143], v[142:143] op_sel:[0,1,1] op_sel_hi:[1,1,1]
  v_pk_fma_f32 v[122:123], v[122:123], v[142:143], v[142:143] op_sel:[0,1,1] op_sel_hi:[1,1,1]
  v_pk_fma_f32 v[124:125], v[124:125], v[142:143], v[142:143] op_sel:[0,1,1] op_sel_hi:[1,1,1]
  v_pk_fma_f32 v[126:127], v[126:127], v[142:143], v[142:143] op_sel:[0,1,1] op_sel_hi:[1,1,1]
  v_rcp_f32 v116, v116
  v_rcp_f32 v117, v117
  v_rcp_f32 v118, v118
  v_rcp_f32 v119, v119
  v_rcp_f32 v120, v120
  v_rcp_f32 v121, v121
  v_rcp_f32 v122, v122
  v_rcp_f32 v123, v123
  v_rcp_f32 v124, v124
  v_rcp_f32 v125, v125
  v_rcp_f32 v126, v126
  v_rcp_f32 v127, v127
  v_pk_mul_f32 v[116:117], v[116:117], v[72:73]
  v_pk_mul_f32 v[118:119], v[118:119], v[74:75]
  v_pk_mul_f32 v[120:121], v[120:121], v[76:77]
  v_pk_mul_f32 v[122:123], v[122:123], v[78:79]
  v_pk_mul_f32 v[124:125], v[124:125], v[80:81]
  v_pk_mul_f32 v[126:127], v[126:127], v[82:83]
  v_cvt_pk_bf16_f32 v128, v116, v117
  v_cvt_pk_bf16_f32 v129, v118, v119
  v_cvt_pk_bf16_f32 v130, v120, v121
  v_cvt_pk_bf16_f32 v131, v122, v123
  v_cvt_pk_bf16_f32 v132, v124, v125
  v_cvt_pk_bf16_f32 v133, v126, v127
  v_permlane16_swap_b32 v128, v130
  v_permlane16_swap_b32 v129, v131
  v_permlane16_swap_b32 v132, v134
  v_permlane16_swap_b32 v133, v135
  buffer_store_dwordx4 v[128:131], v22, s[8:11], s67 offen offset:256 sc1
  buffer_store_dwordx4 v[132:135], v23, s[8:11], s67 offen offset:256 sc1
  s_waitcnt lgkmcnt(4)
  v_mfma_f32_16x16x32_bf16 v[60:63], a[176:179], a[128:131], 0
  s_add_u32 m0, s64, 0
  s_xor_b32 s63, s76, 163840
  ds_read_b128 a[148:151], v3 offset:37888
  v_mfma_f32_16x16x32_bf16 v[64:67], a[180:183], a[128:131], 0
  s_add_u32 s63, s63, s62
  buffer_load_dwordx4 v26, s[28:31], s63 offen offset:0  lds
  v_mfma_f32_16x16x32_bf16 v[68:71], a[184:187], a[128:131], 0
  s_waitcnt lgkmcnt(4)
  s_waitcnt vmcnt(21)
  ds_read_b64_tr_b16 a[0:1], v12 offset:0
  v_mfma_f32_16x16x32_bf16 v[60:63], a[188:191], a[132:135], v[60:63]
  ds_read_b128 a[152:155], v3 offset:38912
  ds_read_b64_tr_b16 a[2:3], v12 offset:512
  v_mfma_f32_16x16x32_bf16 v[64:67], a[192:195], a[132:135], v[64:67]
  buffer_load_dwordx4 v27, s[28:31], s63 offen offset:1024  lds
  v_mfma_f32_16x16x32_bf16 v[68:71], a[196:199], a[132:135], v[68:71]
  s_waitcnt lgkmcnt(6)
  ds_read_b64 v[100:101], v16 offset:49152
  v_mfma_f32_16x16x32_bf16 v[60:63], a[200:203], a[136:139], v[60:63]
  ds_read_b128 a[156:159], v3 offset:39936
  ds_read_b64 v[102:103], v16 offset:50176
  ds_read_b64 v[104:105], v16 offset:51200
  ds_read_b64 v[106:107], v16 offset:52224
  ds_read_b64_tr_b16 a[4:5], v13 offset:0
  v_mfma_f32_16x16x32_bf16 v[64:67], a[204:207], a[136:139], v[64:67]
  ds_read_b64_tr_b16 a[6:7], v13 offset:512
  ds_read_b64_tr_b16 a[8:9], v14 offset:0
  v_mfma_f32_16x16x32_bf16 v[68:71], a[208:211], a[136:139], v[68:71]
  s_waitcnt lgkmcnt(13)
  buffer_load_dwordx4 v28, s[28:31], s63 offen offset:2048  lds
  v_mfma_f32_16x16x32_bf16 v[60:63], a[212:215], a[140:143], v[60:63]
  ds_read_b128 a[128:131], v3 offset:40960
  ds_read_b64_tr_b16 a[10:11], v14 offset:512
  v_mfma_f32_16x16x32_bf16 v[64:67], a[216:219], a[140:143], v[64:67]
  ds_read_b64_tr_b16 a[12:13], v15 offset:0
  ds_read_b64_tr_b16 a[14:15], v15 offset:512
  v_mfma_f32_16x16x32_bf16 v[68:71], a[220:223], a[140:143], v[68:71]
  s_waitcnt lgkmcnt(14)
  s_waitcnt vmcnt(19)
  ds_read_b64_tr_b16 a[16:17], v12 offset:4096
  v_mfma_f32_16x16x32_bf16 v[60:63], a[224:227], a[144:147], v[60:63]
  ds_read_b128 a[132:135], v3 offset:41984
  ds_read_b64_tr_b16 a[18:19], v12 offset:4608
  v_mfma_f32_16x16x32_bf16 v[64:67], a[228:231], a[144:147], v[64:67]
  buffer_load_dwordx4 v29, s[28:31], s63 offen offset:3072  lds
  v_mfma_f32_16x16x32_bf16 v[68:71], a[232:235], a[144:147], v[68:71]
  s_waitcnt lgkmcnt(14)
  s_waitcnt lgkmcnt(10)
  v_max3_u32 v100, v101, v103, v105
  v_mfma_f32_16x16x32_bf16 v[60:63], a[236:239], a[148:151], v[60:63]
  ds_read_b128 a[136:139], v3 offset:43008
  ds_read_b64_tr_b16 a[20:21], v13 offset:4096
  s_waitcnt lgkmcnt(5)
  v_mfma_f32_16x16x32_bf16 v[64:67], a[240:243], a[148:151], v[64:67]
  ds_read_b64_tr_b16 a[22:23], v13 offset:4608
  s_add_u32 m0, s72, 0
  ds_read_b64_tr_b16 a[24:25], v14 offset:4096
  v_mfma_f32_16x16x32_bf16 v[68:71], a[244:247], a[148:151], v[68:71]
  s_xor_b32 s63, s76, 196608
  ds_read_b64_tr_b16 a[26:27], v14 offset:4608
  v_max_u32 v100, v100, v107
  v_mfma_f32_16x16x32_bf16 v[60:63], a[248:251], a[152:155], v[60:63]
  s_add_u32 s63, s63, s62
  ds_read_b128 a[140:143], v3 offset:44032
  buffer_load_dwordx4 v26, s[28:31], s63 offen offset:0  lds
  v_mfma_f32_16x16x32_bf16 v[64:67], a[252:255], a[152:155], v[64:67]
  ds_read_b64_tr_b16 a[28:29], v15 offset:4096
  ds_read_b64_tr_b16 a[30:31], v15 offset:4608
  v_cmp_eq_u32 vcc, -1, v100
  s_cbranch_vccnz Lretry39
Lcont40:
  s_barrier
  v_mfma_f32_16x16x32_bf16 v[68:71], v[144:147], a[152:155], v[68:71]
  buffer_load_dwordx4 v27, s[28:31], s63 offen offset:1024  lds
  v_mfma_f32_16x16x32_bf16 v[60:63], v[148:151], a[156:159], v[60:63]
  ds_read_b128 a[144:147], v3 offset:45056
  s_waitcnt vmcnt(18)
  ds_read_b64_tr_b16 a[32:33], v12 offset:8192
  v_mfma_f32_16x16x32_bf16 v[64:67], v[152:155], a[156:159], v[64:67]
  ds_read_b64_tr_b16 a[34:35], v12 offset:8704
  s_mul_i32 s47, s5, 176128
  s_add_u32 s47, s47, 9437184
  v_mfma_f32_16x16x32_bf16 v[68:71], v[156:159], a[156:159], v[68:71]
  ds_read_b64_tr_b16 a[36:37], v13 offset:8192
  s_mul_i32 s46, s3, 45056
  v_mfma_f32_16x16x32_bf16 v[60:63], v[160:163], a[128:131], v[60:63]
  ds_read_b128 a[148:151], v3 offset:46080
  ds_read_b64_tr_b16 a[38:39], v13 offset:8704
  s_add_u32 s47, s47, s46
  v_mfma_f32_16x16x32_bf16 v[64:67], v[164:167], a[128:131], v[64:67]
  buffer_load_dwordx4 v28, s[28:31], s63 offen offset:2048  lds
  s_xor_b32 s36, s77, 0
  v_mfma_f32_16x16x32_bf16 v[68:71], v[168:171], a[128:131], v[68:71]
  s_waitcnt lgkmcnt(14)
  ds_read_b64_tr_b16 a[40:41], v14 offset:8192
  ds_read_b64_tr_b16 a[42:43], v14 offset:8704
  v_mfma_f32_16x16x32_bf16 v[60:63], v[172:175], a[132:135], v[60:63]
  s_add_u32 s36, s36, s47
  ds_read_b128 a[152:155], v3 offset:47104
  ds_read_b64_tr_b16 a[44:45], v15 offset:8192
  v_mfma_f32_16x16x32_bf16 v[64:67], v[176:179], a[132:135], v[64:67]
  buffer_load_dwordx4 v29, s[28:31], s63 offen offset:3072  lds
  s_xor_b32 s37, s77, 4096
  v_mfma_f32_16x16x32_bf16 v[68:71], v[180:183], a[132:135], v[68:71]
  s_waitcnt lgkmcnt(14)
  ds_read_b64_tr_b16 a[46:47], v15 offset:8704
  s_add_u32 s37, s37, s47
  v_mfma_f32_16x16x32_bf16 v[60:63], v[184:187], a[136:139], v[60:63]
  ds_read_b128 a[156:159], v3 offset:48128
  s_waitcnt vmcnt(16)
  ds_read_b64_tr_b16 a[48:49], v12 offset:12288
  v_mfma_f32_16x16x32_bf16 v[64:67], v[188:191], a[136:139], v[64:67]
  ds_read_b128 v[136:139], v10 offset:512
  s_waitcnt vmcnt(8)
  s_barrier
  buffer_store_dword v11, v19, s[8:11], s79 offen sc1
  v_mfma_f32_16x16x32_bf16 v[68:71], v[192:195], a[136:139], v[68:71]
  s_waitcnt lgkmcnt(14)
  s_xor_b32 s38, s77, 8192
  ds_read_b64_tr_b16 a[50:51], v12 offset:12800
  v_mfma_f32_16x16x32_bf16 v[60:63], v[196:199], a[140:143], v[60:63]
  s_add_u32 s38, s38, s47
  ds_read_b128 a[128:131], v3 offset:49152
  ds_read_b64_tr_b16 a[52:53], v13 offset:12288
  v_mfma_f32_16x16x32_bf16 v[64:67], v[200:203], a[140:143], v[64:67]
  s_xor_b32 s39, s77, 12288
  s_add_u32 s39, s39, s47
  ds_read_b64_tr_b16 a[54:55], v13 offset:12800
  v_mfma_f32_16x16x32_bf16 v[68:71], v[204:207], a[140:143], v[68:71]
  s_waitcnt lgkmcnt(14)
  s_add_u32 m0, s72, 4096
  s_xor_b32 s63, s76, 229376
  s_add_u32 s63, s63, s62
  buffer_load_dwordx4 v26, s[28:31], s63 offen offset:0  lds
  v_mfma_f32_16x16x32_bf16 v[60:63], v[208:211], a[144:147], v[60:63]
  s_xor_b32 s40, s77, 16384
  ds_read_b128 a[132:135], v3 offset:50176
  ds_read_b64_tr_b16 a[56:57], v14 offset:12288
  v_mfma_f32_16x16x32_bf16 v[64:67], v[212:215], a[144:147], v[64:67]
  s_add_u32 s40, s40, s47
  ds_read_b64_tr_b16 a[58:59], v14 offset:12800
  buffer_load_dwordx4 v27, s[28:31], s63 offen offset:1024  lds
  v_mfma_f32_16x16x32_bf16 v[68:71], v[216:219], a[144:147], v[68:71]
  s_waitcnt lgkmcnt(14)
  s_xor_b32 s41, s77, 20480
  ds_read_b64_tr_b16 a[60:61], v15 offset:12288
  v_mfma_f32_16x16x32_bf16 v[60:63], v[220:223], a[148:151], v[60:63]
  s_add_u32 s41, s41, s47
  ds_read_b128 a[136:139], v3 offset:51200
  ds_read_b64_tr_b16 a[62:63], v15 offset:12800
  v_mfma_f32_16x16x32_bf16 v[64:67], v[224:227], a[148:151], v[64:67]
  s_xor_b32 s42, s77, 24576
  ds_read_b64_tr_b16 a[64:65], v12 offset:16384
  v_mfma_f32_16x16x32_bf16 v[68:71], v[228:231], a[148:151], v[68:71]
  s_waitcnt lgkmcnt(14)
  s_add_u32 s42, s42, s47
  buffer_load_dwordx4 v28, s[28:31], s63 offen offset:2048  lds
  ds_read_b64_tr_b16 a[66:67], v12 offset:16896
  v_mfma_f32_16x16x32_bf16 v[60:63], v[232:235], a[152:155], v[60:63]
  s_xor_b32 s43, s77, 28672
  s_add_u32 s43, s43, s47
  ds_read_b128 a[140:143], v3 offset:52224
  v_mfma_f32_16x16x32_bf16 v[64:67], v[236:239], a[152:155], v[64:67]
  ds_read_b64_tr_b16 a[68:69], v13 offset:16384
  s_add_u32 s44, s47, 32768
  ds_read_b64_tr_b16 a[70:71], v13 offset:16896
  v_mfma_f32_16x16x32_bf16 v[68:71], v[240:243], a[152:155], v[68:71]
  s_waitcnt lgkmcnt(14)
  s_add_u32 s45, s47, 36864
  ds_read_b64_tr_b16 a[72:73], v14 offset:16384
  v_mfma_f32_16x16x32_bf16 v[60:63], v[244:247], a[156:159], v[60:63]
  ds_read_b128 a[144:147], v3 offset:53248
  ds_read_b64_tr_b16 a[74:75], v14 offset:16896
  ds_read_b64_tr_b16 a[76:77], v15 offset:16384
  ds_read_b64_tr_b16 a[78:79], v15 offset:16896
  buffer_load_dwordx4 v29, s[28:31], s63 offen offset:3072  lds
  v_mfma_f32_16x16x32_bf16 v[64:67], v[248:251], a[156:159], v[64:67]
  s_add_u32 s46, s47, 40960
  s_cmp_eq_u32 s3, 3
  s_cselect_b32 s47, 0x80000000, 0
  v_or_b32 v4, s47, v2
  v_mfma_f32_16x16x32_bf16 v[68:71], v[252:255], a[156:159], v[68:71]
  s_waitcnt lgkmcnt(14)
.p2align 3
  v_pk_fma_f32 v[60:61], v[48:49], v[136:137], v[60:61] op_sel_hi:[1,0,1] neg_lo:[0,1,0] neg_hi:[0,1,0]
  v_pk_fma_f32 v[62:63], v[50:51], v[136:137], v[62:63] op_sel_hi:[1,0,1] neg_lo:[0,1,0] neg_hi:[0,1,0]
  v_pk_fma_f32 v[64:65], v[52:53], v[136:137], v[64:65] op_sel_hi:[1,0,1] neg_lo:[0,1,0] neg_hi:[0,1,0]
  v_pk_fma_f32 v[66:67], v[54:55], v[136:137], v[66:67] op_sel_hi:[1,0,1] neg_lo:[0,1,0] neg_hi:[0,1,0]
  s_nop 2
  v_pk_fma_f32 v[68:69], v[56:57], v[136:137], v[68:69] op_sel_hi:[1,0,1] neg_lo:[0,1,0] neg_hi:[0,1,0]
  v_pk_fma_f32 v[70:71], v[58:59], v[136:137], v[70:71] op_sel_hi:[1,0,1] neg_lo:[0,1,0] neg_hi:[0,1,0]
  v_pk_mul_f32 v[116:117], v[60:61], v[60:61]
  v_pk_mul_f32 v[118:119], v[62:63], v[62:63]
  v_pk_mul_f32 v[120:121], v[64:65], v[64:65]
  v_pk_mul_f32 v[122:123], v[66:67], v[66:67]
  v_pk_mul_f32 v[124:125], v[68:69], v[68:69]
  v_pk_mul_f32 v[126:127], v[70:71], v[70:71]
  v_pk_fma_f32 v[116:117], v[116:117], v[138:139], v[136:137] op_sel:[0,0,1] op_sel_hi:[1,0,1]
  v_pk_fma_f32 v[118:119], v[118:119], v[138:139], v[136:137] op_sel:[0,0,1] op_sel_hi:[1,0,1]
  v_pk_fma_f32 v[120:121], v[120:121], v[138:139], v[136:137] op_sel:[0,0,1] op_sel_hi:[1,0,1]
  v_pk_fma_f32 v[122:123], v[122:123], v[138:139], v[136:137] op_sel:[0,0,1] op_sel_hi:[1,0,1]
  v_pk_fma_f32 v[124:125], v[124:125], v[138:139], v[136:137] op_sel:[0,0,1] op_sel_hi:[1,0,1]
  v_pk_fma_f32 v[126:127], v[126:127], v[138:139], v[136:137] op_sel:[0,0,1] op_sel_hi:[1,0,1]
  v_pk_mul_f32 v[116:117], v[116:117], v[60:61]
  v_pk_mul_f32 v[118:119], v[118:119], v[62:63]
  v_pk_mul_f32 v[120:121], v[120:121], v[64:65]
  v_pk_mul_f32 v[122:123], v[122:123], v[66:67]
  v_pk_mul_f32 v[124:125], v[124:125], v[68:69]
  v_pk_mul_f32 v[126:127], v[126:127], v[70:71]
  s_waitcnt lgkmcnt(14)
  v_mfma_f32_16x16x32_bf16 v[72:75], a[176:179], a[128:131], 0
  ds_read_b128 a[148:151], v3 offset:54272
  s_add_u32 m0, s72, 8192
  v_mfma_f32_16x16x32_bf16 v[76:79], a[180:183], a[128:131], 0
  s_add_u32 s63, s62, 262144
  buffer_load_dwordx4 v26, s[28:31], s63 offen offset:0  lds
  v_mfma_f32_16x16x32_bf16 v[80:83], a[184:187], a[128:131], 0
  s_waitcnt lgkmcnt(14)
  v_exp_f32 v116, v116
  v_mfma_f32_16x16x32_bf16 v[72:75], a[188:191], a[132:135], v[72:75]
  ds_read_b128 a[152:155], v3 offset:55296
  v_mfma_f32_16x16x32_bf16 v[76:79], a[192:195], a[132:135], v[76:79]
  buffer_load_dwordx4 v27, s[28:31], s63 offen offset:1024  lds
  v_mfma_f32_16x16x32_bf16 v[80:83], a[196:199], a[132:135], v[80:83]
  s_waitcnt lgkmcnt(13)
  v_exp_f32 v117, v117
  v_mfma_f32_16x16x32_bf16 v[72:75], a[200:203], a[136:139], v[72:75]
  ds_read_b128 a[156:159], v3 offset:56320
  v_exp_f32 v118, v118
  v_mfma_f32_16x16x32_bf16 v[76:79], a[204:207], a[136:139], v[76:79]
  buffer_load_dwordx4 v28, s[28:31], s63 offen offset:2048  lds
  v_mfma_f32_16x16x32_bf16 v[80:83], a[208:211], a[136:139], v[80:83]
  s_waitcnt lgkmcnt(10)
  v_exp_f32 v119, v119
  v_mfma_f32_16x16x32_bf16 v[72:75], a[212:215], a[140:143], v[72:75]
  ds_read_b128 a[128:131], v3 offset:57344
  v_exp_f32 v120, v120
  v_mfma_f32_16x16x32_bf16 v[76:79], a[216:219], a[140:143], v[76:79]
  buffer_load_dwordx4 v29, s[28:31], s63 offen offset:3072  lds
  v_exp_f32 v121, v121
  v_mfma_f32_16x16x32_bf16 v[80:83], a[220:223], a[140:143], v[80:83]
  s_waitcnt lgkmcnt(7)
  v_exp_f32 v122, v122
  v_mfma_f32_16x16x32_bf16 v[72:75], a[224:227], a[144:147], v[72:75]
  ds_read_b128 a[132:135], v3 offset:58368
  v_mfma_f32_16x16x32_bf16 v[76:79], a[228:231], a[144:147], v[76:79]
  s_add_u32 m0, s72, 12288
  s_add_u32 s63, s62, 294912
  v_exp_f32 v123, v123
  v_mfma_f32_16x16x32_bf16 v[80:83], a[232:235], a[144:147], v[80:83]
  s_waitcnt lgkmcnt(4)
  buffer_load_dwordx4 v26, s[28:31], s63 offen offset:0  lds
  v_mfma_f32_16x16x32_bf16 v[72:75], a[236:239], a[148:151], v[72:75]
  ds_read_b128 a[136:139], v3 offset:59392
  v_exp_f32 v124, v124
  v_mfma_f32_16x16x32_bf16 v[76:79], a[240:243], a[148:151], v[76:79]
  v_exp_f32 v125, v125
  v_mfma_f32_16x16x32_bf16 v[80:83], a[244:247], a[148:151], v[80:83]
  s_waitcnt lgkmcnt(4)
  buffer_load_dwordx4 v27, s[28:31], s63 offen offset:1024  lds
  v_exp_f32 v126, v126
  v_exp_f32 v127, v127
  v_pk_fma_f32 v[116:117], v[116:117], v[138:139], v[138:139] op_sel:[0,1,1] op_sel_hi:[1,1,1]
  v_pk_fma_f32 v[118:119], v[118:119], v[138:139], v[138:139] op_sel:[0,1,1] op_sel_hi:[1,1,1]
  v_pk_fma_f32 v[120:121], v[120:121], v[138:139], v[138:139] op_sel:[0,1,1] op_sel_hi:[1,1,1]
  v_pk_fma_f32 v[122:123], v[122:123], v[138:139], v[138:139] op_sel:[0,1,1] op_sel_hi:[1,1,1]
  v_pk_fma_f32 v[124:125], v[124:125], v[138:139], v[138:139] op_sel:[0,1,1] op_sel_hi:[1,1,1]
  v_pk_fma_f32 v[126:127], v[126:127], v[138:139], v[138:139] op_sel:[0,1,1] op_sel_hi:[1,1,1]
  v_mfma_f32_16x16x32_bf16 v[72:75], a[248:251], a[152:155], v[72:75]
  ds_read_b128 a[140:143], v3 offset:60416
  v_mfma_f32_16x16x32_bf16 v[76:79], a[252:255], a[152:155], v[76:79]
  v_rcp_f32 v116, v116
  v_mfma_f32_16x16x32_bf16 v[80:83], v[144:147], a[152:155], v[80:83]
  s_waitcnt lgkmcnt(4)
  v_rcp_f32 v117, v117
  v_mfma_f32_16x16x32_bf16 v[72:75], v[148:151], a[156:159], v[72:75]
  ds_read_b128 a[144:147], v3 offset:61440
  v_mfma_f32_16x16x32_bf16 v[76:79], v[152:155], a[156:159], v[76:79]
  buffer_load_dwordx4 v28, s[28:31], s63 offen offset:2048  lds
  v_mfma_f32_16x16x32_bf16 v[80:83], v[156:159], a[156:159], v[80:83]
  s_waitcnt lgkmcnt(4)
  v_rcp_f32 v118, v118
  v_mfma_f32_16x16x32_bf16 v[72:75], v[160:163], a[128:131], v[72:75]
  ds_read_b128 a[148:151], v3 offset:62464
  v_mfma_f32_16x16x32_bf16 v[76:79], v[164:167], a[128:131], v[76:79]
  buffer_load_dwordx4 v29, s[28:31], s63 offen offset:3072  lds
  v_mfma_f32_16x16x32_bf16 v[80:83], v[168:171], a[128:131], v[80:83]
  s_waitcnt lgkmcnt(4)
  v_rcp_f32 v119, v119
  v_mfma_f32_16x16x32_bf16 v[72:75], v[172:175], a[132:135], v[72:75]
  ds_read_b128 a[152:155], v3 offset:63488
  s_cmp_eq_u32 s3, 3
  s_cselect_b32 s1, 0x80000000, 0
  v_rcp_f32 v120, v120
  v_mfma_f32_16x16x32_bf16 v[76:79], v[176:179], a[132:135], v[76:79]
  v_rcp_f32 v121, v121
  v_mfma_f32_16x16x32_bf16 v[80:83], v[180:183], a[132:135], v[80:83]
  s_waitcnt lgkmcnt(4)
  v_rcp_f32 v122, v122
  v_mfma_f32_16x16x32_bf16 v[72:75], v[184:187], a[136:139], v[72:75]
  ds_read_b128 a[156:159], v3 offset:64512
  v_or_b32 v26, s1, v26
  v_mfma_f32_16x16x32_bf16 v[76:79], v[188:191], a[136:139], v[76:79]
  ds_read_b128 v[140:143], v10 offset:768
  v_rcp_f32 v123, v123
  v_mfma_f32_16x16x32_bf16 v[80:83], v[192:195], a[136:139], v[80:83]
  s_waitcnt lgkmcnt(5)
  v_or_b32 v27, s1, v27
  v_or_b32 v28, s1, v28
  v_mfma_f32_16x16x32_bf16 v[72:75], v[196:199], a[140:143], v[72:75]
  v_rcp_f32 v124, v124
  v_or_b32 v29, s1, v29
  v_mfma_f32_16x16x32_bf16 v[76:79], v[200:203], a[140:143], v[76:79]
  s_add_u32 m0, s72, 16384
  s_add_u32 s63, s62, 327680
  buffer_load_dwordx4 v26, s[28:31], s63 offen offset:0  lds
  buffer_load_dwordx4 v27, s[28:31], s63 offen offset:1024  lds
  v_rcp_f32 v125, v125
  v_mfma_f32_16x16x32_bf16 v[80:83], v[204:207], a[140:143], v[80:83]
  s_waitcnt lgkmcnt(4)
  v_rcp_f32 v126, v126
  v_rcp_f32 v127, v127
  v_pk_mul_f32 v[116:117], v[116:117], v[60:61]
  v_pk_mul_f32 v[118:119], v[118:119], v[62:63]
  v_pk_mul_f32 v[120:121], v[120:121], v[64:65]
  v_pk_mul_f32 v[122:123], v[122:123], v[66:67]
  v_pk_mul_f32 v[124:125], v[124:125], v[68:69]
  v_pk_mul_f32 v[126:127], v[126:127], v[70:71]
  v_mfma_f32_16x16x32_bf16 v[72:75], v[208:211], a[144:147], v[72:75]
  buffer_load_dword v24, v25, s[8:11], s78 offen sc1
  v_mfma_f32_16x16x32_bf16 v[76:79], v[212:215], a[144:147], v[76:79]
  buffer_load_dwordx4 v28, s[28:31], s63 offen offset:2048  lds
  v_mfma_f32_16x16x32_bf16 v[80:83], v[216:219], a[144:147], v[80:83]
  s_waitcnt lgkmcnt(3)
  v_cvt_pk_bf16_f32 v128, v116, v117
  v_cvt_pk_bf16_f32 v129, v118, v119
  v_mfma_f32_16x16x32_bf16 v[72:75], v[220:223], a[148:151], v[72:75]
  v_cvt_pk_bf16_f32 v130, v120, v121
  v_cvt_pk_bf16_f32 v131, v122, v123
  v_mfma_f32_16x16x32_bf16 v[76:79], v[224:227], a[148:151], v[76:79]
  buffer_load_dwordx4 v29, s[28:31], s63 offen offset:3072  lds
  v_mfma_f32_16x16x32_bf16 v[80:83], v[228:231], a[148:151], v[80:83]
  s_waitcnt lgkmcnt(2)
  v_cvt_pk_bf16_f32 v132, v124, v125
  v_cvt_pk_bf16_f32 v133, v126, v127
  v_mfma_f32_16x16x32_bf16 v[72:75], v[232:235], a[152:155], v[72:75]
  v_permlane16_swap_b32 v128, v130
  v_permlane16_swap_b32 v129, v131
  v_mfma_f32_16x16x32_bf16 v[76:79], v[236:239], a[152:155], v[76:79]
  v_permlane16_swap_b32 v132, v134
  v_permlane16_swap_b32 v133, v135
  v_mfma_f32_16x16x32_bf16 v[80:83], v[240:243], a[152:155], v[80:83]
  s_waitcnt lgkmcnt(1)
  buffer_store_dwordx4 v[128:131], v22, s[8:11], s67 offen offset:512 sc1
  v_mfma_f32_16x16x32_bf16 v[72:75], v[244:247], a[156:159], v[72:75]
  buffer_store_dwordx4 v[132:135], v23, s[8:11], s67 offen offset:512 sc1
  v_mfma_f32_16x16x32_bf16 v[76:79], v[248:251], a[156:159], v[76:79]
  v_mfma_f32_16x16x32_bf16 v[80:83], v[252:255], a[156:159], v[80:83]
  s_waitcnt lgkmcnt(0)
.p2align 3
  s_nop 3
  v_pk_fma_f32 v[72:73], v[48:49], v[140:141], v[72:73] op_sel_hi:[1,0,1] neg_lo:[0,1,0] neg_hi:[0,1,0]
  v_pk_fma_f32 v[74:75], v[50:51], v[140:141], v[74:75] op_sel_hi:[1,0,1] neg_lo:[0,1,0] neg_hi:[0,1,0]
  v_pk_fma_f32 v[76:77], v[52:53], v[140:141], v[76:77] op_sel_hi:[1,0,1] neg_lo:[0,1,0] neg_hi:[0,1,0]
  v_pk_fma_f32 v[78:79], v[54:55], v[140:141], v[78:79] op_sel_hi:[1,0,1] neg_lo:[0,1,0] neg_hi:[0,1,0]
  v_pk_fma_f32 v[80:81], v[56:57], v[140:141], v[80:81] op_sel_hi:[1,0,1] neg_lo:[0,1,0] neg_hi:[0,1,0]
  v_pk_fma_f32 v[82:83], v[58:59], v[140:141], v[82:83] op_sel_hi:[1,0,1] neg_lo:[0,1,0] neg_hi:[0,1,0]
  v_pk_mul_f32 v[116:117], v[72:73], v[72:73]
  v_pk_mul_f32 v[118:119], v[74:75], v[74:75]
  v_pk_mul_f32 v[120:121], v[76:77], v[76:77]
  v_pk_mul_f32 v[122:123], v[78:79], v[78:79]
  v_pk_mul_f32 v[124:125], v[80:81], v[80:81]
  v_pk_mul_f32 v[126:127], v[82:83], v[82:83]
  v_pk_fma_f32 v[116:117], v[116:117], v[142:143], v[140:141] op_sel:[0,0,1] op_sel_hi:[1,0,1]
  v_pk_fma_f32 v[118:119], v[118:119], v[142:143], v[140:141] op_sel:[0,0,1] op_sel_hi:[1,0,1]
  v_pk_fma_f32 v[120:121], v[120:121], v[142:143], v[140:141] op_sel:[0,0,1] op_sel_hi:[1,0,1]
  v_pk_fma_f32 v[122:123], v[122:123], v[142:143], v[140:141] op_sel:[0,0,1] op_sel_hi:[1,0,1]
  v_pk_fma_f32 v[124:125], v[124:125], v[142:143], v[140:141] op_sel:[0,0,1] op_sel_hi:[1,0,1]
  v_pk_fma_f32 v[126:127], v[126:127], v[142:143], v[140:141] op_sel:[0,0,1] op_sel_hi:[1,0,1]
  v_pk_mul_f32 v[116:117], v[116:117], v[72:73]
  v_pk_mul_f32 v[118:119], v[118:119], v[74:75]
  v_pk_mul_f32 v[120:121], v[120:121], v[76:77]
  v_pk_mul_f32 v[122:123], v[122:123], v[78:79]
  v_pk_mul_f32 v[124:125], v[124:125], v[80:81]
  v_pk_mul_f32 v[126:127], v[126:127], v[82:83]
  v_exp_f32 v116, v116
  v_exp_f32 v117, v117
  v_exp_f32 v118, v118
  v_exp_f32 v119, v119
  v_exp_f32 v120, v120
  v_exp_f32 v121, v121
  v_exp_f32 v122, v122
  v_exp_f32 v123, v123
  v_exp_f32 v124, v124
  v_exp_f32 v125, v125
  v_exp_f32 v126, v126
  v_exp_f32 v127, v127
  s_waitcnt vmcnt(4)
  v_cmp_ne_u32 vcc, s7, v24
  s_cbranch_vccnz Lretry41
Lcont42:
  v_pk_fma_f32 v[116:117], v[116:117], v[142:143], v[142:143] op_sel:[0,1,1] op_sel_hi:[1,1,1]
  buffer_load_dwordx4 v[144:147], v2, s[8:11], s36 offen offset:0 sc1
  v_pk_fma_f32 v[118:119], v[118:119], v[142:143], v[142:143] op_sel:[0,1,1] op_sel_hi:[1,1,1]
  v_pk_fma_f32 v[120:121], v[120:121], v[142:143], v[142:143] op_sel:[0,1,1] op_sel_hi:[1,1,1]
  v_pk_fma_f32 v[122:123], v[122:123], v[142:143], v[142:143] op_sel:[0,1,1] op_sel_hi:[1,1,1]
  v_pk_fma_f32 v[124:125], v[124:125], v[142:143], v[142:143] op_sel:[0,1,1] op_sel_hi:[1,1,1]
  v_pk_fma_f32 v[126:127], v[126:127], v[142:143], v[142:143] op_sel:[0,1,1] op_sel_hi:[1,1,1]
  v_rcp_f32 v116, v116
  buffer_load_dwordx4 v[148:151], v2, s[8:11], s36 offen offset:256 sc1
  v_rcp_f32 v117, v117
  v_rcp_f32 v118, v118
  v_rcp_f32 v119, v119
  v_rcp_f32 v120, v120
  v_rcp_f32 v121, v121
  v_rcp_f32 v122, v122
  v_rcp_f32 v123, v123
  buffer_load_dwordx4 v[152:155], v2, s[8:11], s37 offen offset:0 sc1
  v_rcp_f32 v124, v124
  v_rcp_f32 v125, v125
  v_rcp_f32 v126, v126
  v_rcp_f32 v127, v127
  v_pk_mul_f32 v[116:117], v[116:117], v[72:73]
  v_pk_mul_f32 v[118:119], v[118:119], v[74:75]
  v_pk_mul_f32 v[120:121], v[120:121], v[76:77]
  buffer_load_dwordx4 v[156:159], v2, s[8:11], s37 offen offset:256 sc1
  v_pk_mul_f32 v[122:123], v[122:123], v[78:79]
  v_pk_mul_f32 v[124:125], v[124:125], v[80:81]
  v_pk_mul_f32 v[126:127], v[126:127], v[82:83]
  v_cvt_pk_bf16_f32 v128, v116, v117
  v_cvt_pk_bf16_f32 v129, v118, v119
  v_cvt_pk_bf16_f32 v130, v120, v121
  v_cvt_pk_bf16_f32 v131, v122, v123
  v_cvt_pk_bf16_f32 v132, v124, v125
  v_cvt_pk_bf16_f32 v133, v126, v127
  v_permlane16_swap_b32 v128, v130
  v_permlane16_swap_b32 v129, v131
  v_permlane16_swap_b32 v132, v134
  v_permlane16_swap_b32 v133, v135
  buffer_store_dwordx4 v[128:131], v22, s[8:11], s67 offen offset:768 sc1
  buffer_store_dwordx4 v[132:135], v23, s[8:11], s67 offen offset:768 sc1
  s_cmp_eq_u32 s3, 0
  s_cselect_b32 s65, 1.0, 0
  buffer_load_dwordx4 v[160:163], v2, s[8:11], s38 offen offset:0 sc1
  v_pk_mul_f32 v[48:49], v[32:33], s[64:65] op_sel:[0,1] op_sel_hi:[1,1]
  v_pk_mul_f32 v[50:51], v[34:35], s[64:65] op_sel:[0,1] op_sel_hi:[1,1]
  v_pk_mul_f32 v[52:53], v[36:37], s[64:65] op_sel:[0,1] op_sel_hi:[1,1]
  v_pk_mul_f32 v[54:55], v[38:39], s[64:65] op_sel:[0,1] op_sel_hi:[1,1]
  buffer_load_dwordx4 v[164:167], v2, s[8:11], s38 offen offset:256 sc1
  v_pk_mul_f32 v[56:57], v[40:41], s[64:65] op_sel:[0,1] op_sel_hi:[1,1]
  v_pk_mul_f32 v[58:59], v[42:43], s[64:65] op_sel:[0,1] op_sel_hi:[1,1]
  v_pk_mul_f32 v[60:61], v[44:45], s[64:65] op_sel:[0,1] op_sel_hi:[1,1]
  v_pk_mul_f32 v[62:63], v[46:47], s[64:65] op_sel:[0,1] op_sel_hi:[1,1]
  buffer_load_dwordx4 v[168:171], v2, s[8:11], s39 offen offset:0 sc1
  s_cmp_eq_u32 s3, 1
  s_cselect_b32 s65, 1.0, 0
  v_pk_mul_f32 v[64:65], v[32:33], s[64:65] op_sel:[0,1] op_sel_hi:[1,1]
  v_pk_mul_f32 v[66:67], v[34:35], s[64:65] op_sel:[0,1] op_sel_hi:[1,1]
  v_pk_mul_f32 v[68:69], v[36:37], s[64:65] op_sel:[0,1] op_sel_hi:[1,1]
  v_pk_mul_f32 v[70:71], v[38:39], s[64:65] op_sel:[0,1] op_sel_hi:[1,1]
  buffer_load_dwordx4 v[172:175], v2, s[8:11], s39 offen offset:256 sc1
  v_pk_mul_f32 v[72:73], v[40:41], s[64:65] op_sel:[0,1] op_sel_hi:[1,1]
  v_pk_mul_f32 v[74:75], v[42:43], s[64:65] op_sel:[0,1] op_sel_hi:[1,1]
  v_pk_mul_f32 v[76:77], v[44:45], s[64:65] op_sel:[0,1] op_sel_hi:[1,1]
  v_pk_mul_f32 v[78:79], v[46:47], s[64:65] op_sel:[0,1] op_sel_hi:[1,1]
  buffer_load_dwordx4 v[176:179], v2, s[8:11], s40 offen offset:0 sc1
  s_cmp_eq_u32 s3, 2
  s_cselect_b32 s65, 1.0, 0
  v_pk_mul_f32 v[80:81], v[32:33], s[64:65] op_sel:[0,1] op_sel_hi:[1,1]
  v_pk_mul_f32 v[82:83], v[34:35], s[64:65] op_sel:[0,1] op_sel_hi:[1,1]
  v_pk_mul_f32 v[84:85], v[36:37], s[64:65] op_sel:[0,1] op_sel_hi:[1,1]
  v_pk_mul_f32 v[86:87], v[38:39], s[64:65] op_sel:[0,1] op_sel_hi:[1,1]
  buffer_load_dwordx4 v[180:183], v2, s[8:11], s40 offen offset:256 sc1
  v_pk_mul_f32 v[88:89], v[40:41], s[64:65] op_sel:[0,1] op_sel_hi:[1,1]
  v_pk_mul_f32 v[90:91], v[42:43], s[64:65] op_sel:[0,1] op_sel_hi:[1,1]
  v_pk_mul_f32 v[92:93], v[44:45], s[64:65] op_sel:[0,1] op_sel_hi:[1,1]
  v_pk_mul_f32 v[94:95], v[46:47], s[64:65] op_sel:[0,1] op_sel_hi:[1,1]
  buffer_load_dwordx4 v[184:187], v2, s[8:11], s41 offen offset:0 sc1
  s_cmp_eq_u32 s3, 3
  s_cselect_b32 s65, 1.0, 0
  v_pk_mul_f32 v[96:97], v[32:33], s[64:65] op_sel:[0,1] op_sel_hi:[1,1]
  v_pk_mul_f32 v[98:99], v[34:35], s[64:65] op_sel:[0,1] op_sel_hi:[1,1]
Lpage6:
  s_cbranch_execz Lback6
  v_pk_mul_f32 v[100:101], v[36:37], s[64:65] op_sel:[0,1] op_sel_hi:[1,1]
  v_pk_mul_f32 v[102:103], v[38:39], s[64:65] op_sel:[0,1] op_sel_hi:[1,1]
  buffer_load_dwordx4 v[188:191], v2, s[8:11], s41 offen offset:256 sc1
  v_pk_mul_f32 v[104:105], v[40:41], s[64:65] op_sel:[0,1] op_sel_hi:[1,1]
  v_pk_mul_f32 v[106:107], v[42:43], s[64:65] op_sel:[0,1] op_sel_hi:[1,1]
  v_pk_mul_f32 v[108:109], v[44:45], s[64:65] op_sel:[0,1] op_sel_hi:[1,1]
  v_pk_mul_f32 v[110:111], v[46:47], s[64:65] op_sel:[0,1] op_sel_hi:[1,1]
  s_waitcnt vmcnt(13)
  v_mfma_f32_16x16x32_bf16 v[48:51], a[0:3], v[144:147], v[48:51]
  buffer_load_dwordx4 v[192:195], v2, s[8:11], s42 offen offset:0 sc1
  v_mfma_f32_16x16x32_bf16 v[52:55], a[4:7], v[144:147], v[52:55]
  v_mfma_f32_16x16x32_bf16 v[56:59], a[8:11], v[144:147], v[56:59]
  s_lshl_b32 s66, s3, 14
  s_add_u32 s66, s66, 65536
  v_subrev_u32 v26, s66, v12
  v_mfma_f32_16x16x32_bf16 v[60:63], a[12:15], v[144:147], v[60:63]
  s_waitcnt vmcnt(13)
  v_mfma_f32_16x16x32_bf16 v[64:67], a[0:3], v[148:151], v[64:67]
  buffer_load_dwordx4 v[196:199], v2, s[8:11], s42 offen offset:256 sc1
  v_mfma_f32_16x16x32_bf16 v[68:71], a[4:7], v[148:151], v[68:71]
  v_subrev_u32 v27, s66, v13
  v_subrev_u32 v28, s66, v14
  v_mfma_f32_16x16x32_bf16 v[72:75], a[8:11], v[148:151], v[72:75]
  v_mfma_f32_16x16x32_bf16 v[76:79], a[12:15], v[148:151], v[76:79]
  s_waitcnt vmcnt(13)
  v_subrev_u32 v29, s66, v15
  v_mfma_f32_16x16x32_bf16 v[48:51], a[16:19], v[152:155], v[48:51]
  buffer_load_dwordx4 v[200:203], v2, s[8:11], s43 offen offset:0 sc1
  v_mfma_f32_16x16x32_bf16 v[52:55], a[20:23], v[152:155], v[52:55]
  ds_read_b64_tr_b16 a[80:81], v26 offset:0
  v_mfma_f32_16x16x32_bf16 v[56:59], a[24:27], v[152:155], v[56:59]
  ds_read_b64_tr_b16 a[82:83], v26 offset:512
  v_mfma_f32_16x16x32_bf16 v[60:63], a[28:31], v[152:155], v[60:63]
  s_waitcnt vmcnt(13)
  ds_read_b64_tr_b16 a[84:85], v27 offset:0
  v_mfma_f32_16x16x32_bf16 v[64:67], a[16:19], v[156:159], v[64:67]
  buffer_load_dwordx4 v[204:207], v2, s[8:11], s43 offen offset:256 sc1
  v_mfma_f32_16x16x32_bf16 v[68:71], a[20:23], v[156:159], v[68:71]
  ds_read_b64_tr_b16 a[86:87], v27 offset:512
  v_mfma_f32_16x16x32_bf16 v[72:75], a[24:27], v[156:159], v[72:75]
  ds_read_b64_tr_b16 a[88:89], v28 offset:0
  v_mfma_f32_16x16x32_bf16 v[76:79], a[28:31], v[156:159], v[76:79]
  s_waitcnt vmcnt(11)
  ds_read_b64_tr_b16 a[90:91], v28 offset:512
  v_mfma_f32_16x16x32_bf16 v[48:51], a[32:35], v[160:163], v[48:51]
  buffer_load_dwordx4 v[208:211], v2, s[8:11], s44 offen offset:0 sc1
  v_mfma_f32_16x16x32_bf16 v[52:55], a[36:39], v[160:163], v[52:55]
  ds_read_b64_tr_b16 a[92:93], v29 offset:0
  v_mfma_f32_16x16x32_bf16 v[56:59], a[40:43], v[160:163], v[56:59]
  ds_read_b64_tr_b16 a[94:95], v29 offset:512
  v_mfma_f32_16x16x32_bf16 v[60:63], a[44:47], v[160:163], v[60:63]
  s_waitcnt vmcnt(11)
  ds_read_b64_tr_b16 a[96:97], v12 offset:0
  v_mfma_f32_16x16x32_bf16 v[64:67], a[32:35], v[164:167], v[64:67]
  buffer_load_dwordx4 v[212:215], v2, s[8:11], s44 offen offset:256 sc1
  v_mfma_f32_16x16x32_bf16 v[68:71], a[36:39], v[164:167], v[68:71]
  ds_read_b64_tr_b16 a[98:99], v12 offset:512
  v_mfma_f32_16x16x32_bf16 v[72:75], a[40:43], v[164:167], v[72:75]
  ds_read_b64_tr_b16 a[100:101], v13 offset:0
  v_mfma_f32_16x16x32_bf16 v[76:79], a[44:47], v[164:167], v[76:79]
  s_waitcnt vmcnt(11)
  ds_read_b64_tr_b16 a[102:103], v13 offset:512
  v_mfma_f32_16x16x32_bf16 v[48:51], a[48:51], v[168:171], v[48:51]
  buffer_load_dwordx4 v[216:219], v2, s[8:11], s45 offen offset:0 sc1
  v_mfma_f32_16x16x32_bf16 v[52:55], a[52:55], v[168:171], v[52:55]
  ds_read_b64_tr_b16 a[104:105], v14 offset:0
  v_mfma_f32_16x16x32_bf16 v[56:59], a[56:59], v[168:171], v[56:59]
  ds_read_b64_tr_b16 a[106:107], v14 offset:512
  v_mfma_f32_16x16x32_bf16 v[60:63], a[60:63], v[168:171], v[60:63]
  s_waitcnt vmcnt(11)
  v_mfma_f32_16x16x32_bf16 v[64:67], a[48:51], v[172:175], v[64:67]
  buffer_load_dwordx4 v[220:223], v2, s[8:11], s45 offen offset:256 sc1
  v_mfma_f32_16x16x32_bf16 v[68:71], a[52:55], v[172:175], v[68:71]
  ds_read_b64_tr_b16 a[108:109], v15 offset:0
  v_mfma_f32_16x16x32_bf16 v[72:75], a[56:59], v[172:175], v[72:75]
  ds_read_b64_tr_b16 a[110:111], v15 offset:512
  s_mul_i32 s65, s3, 4608
  v_mfma_f32_16x16x32_bf16 v[76:79], a[60:63], v[172:175], v[76:79]
  s_waitcnt vmcnt(11)
  s_add_u32 s65, s65, 0
  v_mfma_f32_16x16x32_bf16 v[48:51], a[64:67], v[176:179], v[48:51]
  buffer_load_dwordx4 v[224:227], v4, s[8:11], s46 offen offset:0 sc1
  v_mfma_f32_16x16x32_bf16 v[52:55], a[68:71], v[176:179], v[52:55]
  ds_read_b64_tr_b16 a[112:113], v12 offset:4096
  v_lshl_add_u32 v8, v21, 5, v3
  v_mfma_f32_16x16x32_bf16 v[56:59], a[72:75], v[176:179], v[56:59]
  ds_read_b64_tr_b16 a[114:115], v12 offset:4608
  v_mfma_f32_16x16x32_bf16 v[60:63], a[76:79], v[176:179], v[60:63]
  s_waitcnt vmcnt(11)
  ds_read_b64_tr_b16 a[116:117], v13 offset:4096
  v_mfma_f32_16x16x32_bf16 v[64:67], a[64:67], v[180:183], v[64:67]
  buffer_load_dwordx4 v[228:231], v4, s[8:11], s46 offen offset:256 sc1
  v_mfma_f32_16x16x32_bf16 v[68:71], a[68:71], v[180:183], v[68:71]
  ds_read_b64_tr_b16 a[118:119], v13 offset:4608
  v_add_u32 v8, s65, v8
  v_mfma_f32_16x16x32_bf16 v[72:75], a[72:75], v[180:183], v[72:75]
  ds_read_b64_tr_b16 a[120:121], v14 offset:4096
  v_mfma_f32_16x16x32_bf16 v[76:79], a[76:79], v[180:183], v[76:79]
  s_waitcnt vmcnt(11)
  s_waitcnt lgkmcnt(13)
  ds_read_b64_tr_b16 a[122:123], v14 offset:4608
  v_mfma_f32_16x16x32_bf16 v[48:51], a[80:83], v[184:187], v[48:51]
  buffer_load_dwordx4 v[232:235], v2, s[8:11], s36 offen offset:512 sc1
  v_mfma_f32_16x16x32_bf16 v[52:55], a[84:87], v[184:187], v[52:55]
  ds_read_b64_tr_b16 a[124:125], v15 offset:4096
  s_lshr_b32 s65, s3, 1
  v_mfma_f32_16x16x32_bf16 v[56:59], a[88:91], v[184:187], v[56:59]
  ds_read_b64_tr_b16 a[126:127], v15 offset:4608
  s_mul_i32 s65, s65, 18176
  v_mfma_f32_16x16x32_bf16 v[60:63], a[92:95], v[184:187], v[60:63]
  s_waitcnt vmcnt(11)
  ds_read_b64_tr_b16 a[128:129], v12 offset:8192
  v_mfma_f32_16x16x32_bf16 v[64:67], a[80:83], v[188:191], v[64:67]
  buffer_load_dwordx4 v[236:239], v2, s[8:11], s37 offen offset:512 sc1
  s_lshl_b32 s68, s3, 7
  v_mfma_f32_16x16x32_bf16 v[68:71], a[84:87], v[188:191], v[68:71]
  ds_read_b64_tr_b16 a[130:131], v12 offset:8704
  s_add_u32 s65, s65, s68
  v_mfma_f32_16x16x32_bf16 v[72:75], a[88:91], v[188:191], v[72:75]
  ds_read_b64_tr_b16 a[132:133], v13 offset:8192
  s_add_u32 s65, s65, 0
  v_mfma_f32_16x16x32_bf16 v[76:79], a[92:95], v[188:191], v[76:79]
  s_waitcnt vmcnt(11)
  s_waitcnt lgkmcnt(11)
  ds_read_b64_tr_b16 a[134:135], v13 offset:8704
  v_mfma_f32_16x16x32_bf16 v[48:51], a[96:99], v[192:195], v[48:51]
  buffer_load_dwordx4 v[240:243], v2, s[8:11], s38 offen offset:512 sc1
  v_mfma_f32_16x16x32_bf16 v[52:55], a[100:103], v[192:195], v[52:55]
  ds_read_b64_tr_b16 a[136:137], v14 offset:8192
  v_and_b32 v31, 7, v1
  v_mfma_f32_16x16x32_bf16 v[56:59], a[104:107], v[192:195], v[56:59]
  ds_read_b64_tr_b16 a[138:139], v14 offset:8704
  v_mfma_f32_16x16x32_bf16 v[60:63], a[108:111], v[192:195], v[60:63]
  s_waitcnt vmcnt(11)
  ds_read_b64_tr_b16 a[140:141], v15 offset:8192
  v_mfma_f32_16x16x32_bf16 v[64:67], a[96:99], v[196:199], v[64:67]
  buffer_load_dwordx4 v[244:247], v2, s[8:11], s39 offen offset:512 sc1
  v_mfma_f32_16x16x32_bf16 v[68:71], a[100:103], v[196:199], v[68:71]
  ds_read_b64_tr_b16 a[142:143], v15 offset:8704
  v_lshrrev_b32 v16, 3, v1
  v_mfma_f32_16x16x32_bf16 v[72:75], a[104:107], v[196:199], v[72:75]
  ds_read_b64_tr_b16 a[144:145], v12 offset:12288
  v_mfma_f32_16x16x32_bf16 v[76:79], a[108:111], v[196:199], v[76:79]
  s_waitcnt vmcnt(11)
  s_waitcnt lgkmcnt(9)
  ds_read_b64_tr_b16 a[146:147], v12 offset:12800
  v_mfma_f32_16x16x32_bf16 v[48:51], a[112:115], v[200:203], v[48:51]
  buffer_load_dwordx4 v[248:251], v2, s[8:11], s40 offen offset:512 sc1
  v_mfma_f32_16x16x32_bf16 v[52:55], a[116:119], v[200:203], v[52:55]
  ds_read_b64_tr_b16 a[148:149], v13 offset:12288
  v_mul_u32_u24 v9, 576, v31
  v_mfma_f32_16x16x32_bf16 v[56:59], a[120:123], v[200:203], v[56:59]
  ds_read_b64_tr_b16 a[150:151], v13 offset:12800
  v_mfma_f32_16x16x32_bf16 v[60:63], a[124:127], v[200:203], v[60:63]
  s_waitcnt vmcnt(11)
  ds_read_b64_tr_b16 a[152:153], v14 offset:12288
  v_mfma_f32_16x16x32_bf16 v[64:67], a[112:115], v[204:207], v[64:67]
  buffer_load_dwordx4 v[252:255], v2, s[8:11], s41 offen offset:512 sc1
  v_mfma_f32_16x16x32_bf16 v[68:71], a[116:119], v[204:207], v[68:71]
  ds_read_b64_tr_b16 a[154:155], v14 offset:12800
  v_lshl_add_u32 v9, v16, 4, v9
  v_mfma_f32_16x16x32_bf16 v[72:75], a[120:123], v[204:207], v[72:75]
  ds_read_b64_tr_b16 a[156:157], v15 offset:12288
  v_mfma_f32_16x16x32_bf16 v[76:79], a[124:127], v[204:207], v[76:79]
  s_waitcnt vmcnt(11)
  s_waitcnt lgkmcnt(7)
  ds_read_b64_tr_b16 a[158:159], v15 offset:12800
  v_mfma_f32_16x16x32_bf16 v[48:51], a[128:131], v[208:211], v[48:51]
  buffer_load_dwordx4 v[144:147], v2, s[8:11], s42 offen offset:512 sc1
  v_mfma_f32_16x16x32_bf16 v[52:55], a[132:135], v[208:211], v[52:55]
  ds_read_b64_tr_b16 a[160:161], v12 offset:16384
  v_add_u32 v9, s65, v9
  v_mfma_f32_16x16x32_bf16 v[56:59], a[136:139], v[208:211], v[56:59]
  ds_read_b64_tr_b16 a[162:163], v12 offset:16896
  v_mfma_f32_16x16x32_bf16 v[60:63], a[140:143], v[208:211], v[60:63]
  s_waitcnt vmcnt(11)
  ds_read_b64_tr_b16 a[164:165], v13 offset:16384
  v_mfma_f32_16x16x32_bf16 v[64:67], a[128:131], v[212:215], v[64:67]
  buffer_load_dwordx4 v[148:151], v2, s[8:11], s43 offen offset:512 sc1
  v_mfma_f32_16x16x32_bf16 v[68:71], a[132:135], v[212:215], v[68:71]
  ds_read_b64_tr_b16 a[166:167], v13 offset:16896
  v_lshlrev_b32 v16, 10, v16
  v_mfma_f32_16x16x32_bf16 v[72:75], a[136:139], v[212:215], v[72:75]
  ds_read_b64_tr_b16 a[168:169], v14 offset:16384
  v_mfma_f32_16x16x32_bf16 v[76:79], a[140:143], v[212:215], v[76:79]
  s_waitcnt vmcnt(11)
  s_waitcnt lgkmcnt(5)
  ds_read_b64_tr_b16 a[170:171], v14 offset:16896
  v_mfma_f32_16x16x32_bf16 v[48:51], a[144:147], v[216:219], v[48:51]
  buffer_load_dwordx4 v[152:155], v2, s[8:11], s44 offen offset:512 sc1
  v_mfma_f32_16x16x32_bf16 v[52:55], a[148:151], v[216:219], v[52:55]
  ds_read_b64_tr_b16 a[172:173], v15 offset:16384
  v_lshl_add_u32 v16, v31, 4, v16
  v_mfma_f32_16x16x32_bf16 v[56:59], a[152:155], v[216:219], v[56:59]
  ds_read_b64_tr_b16 a[174:175], v15 offset:16896
  v_mfma_f32_16x16x32_bf16 v[60:63], a[156:159], v[216:219], v[60:63]
  s_waitcnt vmcnt(11)
  v_mfma_f32_16x16x32_bf16 v[64:67], a[144:147], v[220:223], v[64:67]
  buffer_load_dwordx4 v[156:159], v2, s[8:11], s45 offen offset:512 sc1
  v_mfma_f32_16x16x32_bf16 v[68:71], a[148:151], v[220:223], v[68:71]
  v_mfma_f32_16x16x32_bf16 v[72:75], a[152:155], v[220:223], v[72:75]
  s_lshl_b32 s68, s5, 16
  v_mfma_f32_16x16x32_bf16 v[76:79], a[156:159], v[220:223], v[76:79]
  s_waitcnt vmcnt(11)
  s_waitcnt lgkmcnt(0)
  s_lshl_b32 s65, s3, 13
  v_mfma_f32_16x16x32_bf16 v[48:51], a[160:163], v[224:227], v[48:51]
  buffer_load_dwordx4 v[160:163], v4, s[8:11], s46 offen offset:512 sc1
  s_add_u32 s68, s68, s65
  v_mfma_f32_16x16x32_bf16 v[52:55], a[164:167], v[224:227], v[52:55]
  v_mfma_f32_16x16x32_bf16 v[56:59], a[168:171], v[224:227], v[56:59]
  s_lshl_b32 s65, s6, 7
  v_mfma_f32_16x16x32_bf16 v[60:63], a[172:175], v[224:227], v[60:63]
  s_waitcnt vmcnt(11)
  s_add_u32 s68, s68, s65
  v_mfma_f32_16x16x32_bf16 v[64:67], a[160:163], v[228:231], v[64:67]
  buffer_load_dwordx4 v[164:167], v2, s[8:11], s36 offen offset:768 sc1
  s_add_u32 s69, s68, 32768
  v_mfma_f32_16x16x32_bf16 v[68:71], a[164:167], v[228:231], v[68:71]
  s_barrier
  v_mfma_f32_16x16x32_bf16 v[72:75], a[168:171], v[228:231], v[72:75]
  s_waitcnt vmcnt(9)
  v_max3_u32 v30, v232, v236, v240
  v_cmp_eq_u32 vcc, -1, v30
  v_mfma_f32_16x16x32_bf16 v[76:79], a[172:175], v[228:231], v[76:79]
  s_cbranch_vccnz Lretry44
Lcont45:
  v_mfma_f32_16x16x32_bf16 v[80:83], a[0:3], v[232:235], v[80:83]
  buffer_load_dwordx4 v[168:171], v2, s[8:11], s37 offen offset:768 sc1
  v_mfma_f32_16x16x32_bf16 v[84:87], a[4:7], v[232:235], v[84:87]
  v_mfma_f32_16x16x32_bf16 v[88:91], a[8:11], v[232:235], v[88:91]
  ds_write_b128 v8, v[48:51] offset:0
  v_mfma_f32_16x16x32_bf16 v[92:95], a[12:15], v[232:235], v[92:95]
  v_mfma_f32_16x16x32_bf16 v[80:83], a[16:19], v[236:239], v[80:83]
  buffer_load_dwordx4 v[172:175], v2, s[8:11], s38 offen offset:768 sc1
  v_mfma_f32_16x16x32_bf16 v[84:87], a[20:23], v[236:239], v[84:87]
  v_mfma_f32_16x16x32_bf16 v[88:91], a[24:27], v[236:239], v[88:91]
  ds_write_b128 v8, v[52:55] offset:1152
  v_mfma_f32_16x16x32_bf16 v[92:95], a[28:31], v[236:239], v[92:95]
  v_mfma_f32_16x16x32_bf16 v[80:83], a[32:35], v[240:243], v[80:83]
  buffer_load_dwordx4 v[176:179], v2, s[8:11], s39 offen offset:768 sc1
  v_mfma_f32_16x16x32_bf16 v[84:87], a[36:39], v[240:243], v[84:87]
  s_waitcnt vmcnt(9)
  v_max3_u32 v30, v244, v248, v252
  v_cmp_eq_u32 vcc, -1, v30
  v_mfma_f32_16x16x32_bf16 v[88:91], a[40:43], v[240:243], v[88:91]
  v_mfma_f32_16x16x32_bf16 v[92:95], a[44:47], v[240:243], v[92:95]
  s_cbranch_vccnz Lretry46
Lcont47:
  ds_write_b128 v8, v[56:59] offset:2304
  v_mfma_f32_16x16x32_bf16 v[80:83], a[48:51], v[244:247], v[80:83]
  buffer_load_dwordx4 v[180:183], v2, s[8:11], s40 offen offset:768 sc1
  v_mfma_f32_16x16x32_bf16 v[84:87], a[52:55], v[244:247], v[84:87]
  v_mfma_f32_16x16x32_bf16 v[88:91], a[56:59], v[244:247], v[88:91]
  v_mfma_f32_16x16x32_bf16 v[92:95], a[60:63], v[244:247], v[92:95]
  ds_write_b128 v8, v[60:63] offset:3456
  v_mfma_f32_16x16x32_bf16 v[80:83], a[64:67], v[248:251], v[80:83]
  buffer_load_dwordx4 v[184:187], v2, s[8:11], s41 offen offset:768 sc1
  v_mfma_f32_16x16x32_bf16 v[84:87], a[68:71], v[248:251], v[84:87]
  v_mfma_f32_16x16x32_bf16 v[88:91], a[72:75], v[248:251], v[88:91]
  v_mfma_f32_16x16x32_bf16 v[92:95], a[76:79], v[248:251], v[92:95]
  v_mfma_f32_16x16x32_bf16 v[80:83], a[80:83], v[252:255], v[80:83]
  buffer_load_dwordx4 v[188:191], v2, s[8:11], s42 offen offset:768 sc1
  v_mfma_f32_16x16x32_bf16 v[84:87], a[84:87], v[252:255], v[84:87]
  ds_write_b128 v8, v[64:67] offset:18432
  v_mfma_f32_16x16x32_bf16 v[88:91], a[88:91], v[252:255], v[88:91]
  s_waitcnt vmcnt(9)
  v_max3_u32 v30, v144, v148, v152
  v_cmp_eq_u32 vcc, -1, v30
  v_mfma_f32_16x16x32_bf16 v[92:95], a[92:95], v[252:255], v[92:95]
  s_cbranch_vccnz Lretry48
Lcont49:
  v_mfma_f32_16x16x32_bf16 v[80:83], a[96:99], v[144:147], v[80:83]
  buffer_load_dwordx4 v[192:195], v2, s[8:11], s43 offen offset:768 sc1
  v_mfma_f32_16x16x32_bf16 v[84:87], a[100:103], v[144:147], v[84:87]
  ds_write_b128 v8, v[68:71] offset:19584
  v_mfma_f32_16x16x32_bf16 v[88:91], a[104:107], v[144:147], v[88:91]
  v_mfma_f32_16x16x32_bf16 v[92:95], a[108:111], v[144:147], v[92:95]
  v_mfma_f32_16x16x32_bf16 v[80:83], a[112:115], v[148:151], v[80:83]
  buffer_load_dwordx4 v[196:199], v2, s[8:11], s44 offen offset:768 sc1
  v_mfma_f32_16x16x32_bf16 v[84:87], a[116:119], v[148:151], v[84:87]
  ds_write_b128 v8, v[72:75] offset:20736
  v_mfma_f32_16x16x32_bf16 v[88:91], a[120:123], v[148:151], v[88:91]
  v_mfma_f32_16x16x32_bf16 v[92:95], a[124:127], v[148:151], v[92:95]
  v_mfma_f32_16x16x32_bf16 v[80:83], a[128:131], v[152:155], v[80:83]
  buffer_load_dwordx4 v[200:203], v2, s[8:11], s45 offen offset:768 sc1
  v_mfma_f32_16x16x32_bf16 v[84:87], a[132:135], v[152:155], v[84:87]
  s_waitcnt vmcnt(10)
  v_max3_u32 v30, v156, v160, v160
  v_cmp_eq_u32 vcc, -1, v30
  v_mfma_f32_16x16x32_bf16 v[88:91], a[136:139], v[152:155], v[88:91]
  ds_write_b128 v8, v[76:79] offset:21888
  v_mfma_f32_16x16x32_bf16 v[92:95], a[140:143], v[152:155], v[92:95]
  s_cbranch_vccnz Lretry50
Lcont51:
  v_mfma_f32_16x16x32_bf16 v[80:83], a[144:147], v[156:159], v[80:83]
  buffer_load_dwordx4 v[204:207], v4, s[8:11], s46 offen offset:768 sc1
  v_mfma_f32_16x16x32_bf16 v[84:87], a[148:151], v[156:159], v[84:87]
  v_mfma_f32_16x16x32_bf16 v[88:91], a[152:155], v[156:159], v[88:91]
  v_mfma_f32_16x16x32_bf16 v[92:95], a[156:159], v[156:159], v[92:95]
  v_mfma_f32_16x16x32_bf16 v[80:83], a[160:163], v[160:163], v[80:83]
  v_mfma_f32_16x16x32_bf16 v[84:87], a[164:167], v[160:163], v[84:87]
  s_waitcnt lgkmcnt(0)
  s_barrier
  ds_read_b128 v[112:115], v9 offset:0
  v_mfma_f32_16x16x32_bf16 v[88:91], a[168:171], v[160:163], v[88:91]
  s_waitcnt vmcnt(8)
  v_max3_u32 v30, v164, v168, v172
  v_cmp_eq_u32 vcc, -1, v30
  v_mfma_f32_16x16x32_bf16 v[92:95], a[172:175], v[160:163], v[92:95]
  s_cbranch_vccnz Lretry52
Lcont53:
  ds_read_b128 v[116:119], v9 offset:288
  v_mfma_f32_16x16x32_bf16 v[96:99], a[0:3], v[164:167], v[96:99]
  ds_read_b128 v[120:123], v9 offset:4608
  v_mfma_f32_16x16x32_bf16 v[100:103], a[4:7], v[164:167], v[100:103]
  ds_read_b128 v[124:127], v9 offset:4896
  v_mfma_f32_16x16x32_bf16 v[104:107], a[8:11], v[164:167], v[104:107]
  ds_read_b128 v[128:131], v9 offset:9216
  v_mfma_f32_16x16x32_bf16 v[108:111], a[12:15], v[164:167], v[108:111]
  v_mfma_f32_16x16x32_bf16 v[96:99], a[16:19], v[168:171], v[96:99]
  ds_read_b128 v[132:135], v9 offset:9504
  v_mfma_f32_16x16x32_bf16 v[100:103], a[20:23], v[168:171], v[100:103]
  ds_read_b128 v[136:139], v9 offset:13824
  v_mfma_f32_16x16x32_bf16 v[104:107], a[24:27], v[168:171], v[104:107]
  ds_read_b128 v[140:143], v9 offset:14112
  v_mfma_f32_16x16x32_bf16 v[108:111], a[28:31], v[168:171], v[108:111]
  v_mfma_f32_16x16x32_bf16 v[96:99], a[32:35], v[172:175], v[96:99]
  v_mfma_f32_16x16x32_bf16 v[100:103], a[36:39], v[172:175], v[100:103]
  s_waitcnt vmcnt(5)
  v_max3_u32 v30, v176, v180, v184
  v_cmp_eq_u32 vcc, -1, v30
  v_mfma_f32_16x16x32_bf16 v[104:107], a[40:43], v[172:175], v[104:107]
  ds_write_b128 v8, v[80:83] offset:36864
  v_mfma_f32_16x16x32_bf16 v[108:111], a[44:47], v[172:175], v[108:111]
  s_cbranch_vccnz Lretry54
Lcont55:
  v_mfma_f32_16x16x32_bf16 v[96:99], a[48:51], v[176:179], v[96:99]
  s_waitcnt lgkmcnt(5)
  v_add_f32 v112, v112, v120
  v_add_f32 v113, v113, v121
  v_mfma_f32_16x16x32_bf16 v[100:103], a[52:55], v[176:179], v[100:103]
  v_add_f32 v114, v114, v122
  v_add_f32 v115, v115, v123
  v_mfma_f32_16x16x32_bf16 v[104:107], a[56:59], v[176:179], v[104:107]
  v_add_f32 v116, v116, v124
  v_add_f32 v117, v117, v125
  v_mfma_f32_16x16x32_bf16 v[108:111], a[60:63], v[176:179], v[108:111]
  ds_write_b128 v8, v[84:87] offset:38016
  v_add_f32 v118, v118, v126
  v_mfma_f32_16x16x32_bf16 v[96:99], a[64:67], v[180:183], v[96:99]
  v_add_f32 v119, v119, v127
  v_mfma_f32_16x16x32_bf16 v[100:103], a[68:71], v[180:183], v[100:103]
  s_waitcnt lgkmcnt(4)
  v_add_f32 v112, v112, v128
  v_add_f32 v113, v113, v129
  v_mfma_f32_16x16x32_bf16 v[104:107], a[72:75], v[180:183], v[104:107]
  v_add_f32 v114, v114, v130
  v_mfma_f32_16x16x32_bf16 v[108:111], a[76:79], v[180:183], v[108:111]
  v_add_f32 v115, v115, v131
  v_add_f32 v116, v116, v132
  v_mfma_f32_16x16x32_bf16 v[96:99], a[80:83], v[184:187], v[96:99]
  ds_write_b128 v8, v[88:91] offset:39168
  v_add_f32 v117, v117, v133
  v_mfma_f32_16x16x32_bf16 v[100:103], a[84:87], v[184:187], v[100:103]
  s_waitcnt vmcnt(3)
  v_max3_u32 v30, v188, v192, v192
  v_cmp_eq_u32 vcc, -1, v30
  v_mfma_f32_16x16x32_bf16 v[104:107], a[88:91], v[184:187], v[104:107]
  v_add_f32 v118, v118, v134
  v_add_f32 v119, v119, v135
  v_mfma_f32_16x16x32_bf16 v[108:111], a[92:95], v[184:187], v[108:111]
  s_cbranch_vccnz Lretry56
Lcont57:
  v_mfma_f32_16x16x32_bf16 v[96:99], a[96:99], v[188:191], v[96:99]
  s_waitcnt lgkmcnt(3)
  v_add_f32 v112, v112, v136
  v_add_f32 v113, v113, v137
  v_mfma_f32_16x16x32_bf16 v[100:103], a[100:103], v[188:191], v[100:103]
  ds_write_b128 v8, v[92:95] offset:40320
  v_add_f32 v114, v114, v138
  v_mfma_f32_16x16x32_bf16 v[104:107], a[104:107], v[188:191], v[104:107]
  v_add_f32 v115, v115, v139
  v_add_f32 v116, v116, v140
  v_mfma_f32_16x16x32_bf16 v[108:111], a[108:111], v[188:191], v[108:111]
  v_add_f32 v117, v117, v141
  v_add_f32 v118, v118, v142
  v_mfma_f32_16x16x32_bf16 v[96:99], a[112:115], v[192:195], v[96:99]
  v_add_f32 v119, v119, v143
  v_cvt_pk_bf16_f32 v32, v112, v113
  v_mfma_f32_16x16x32_bf16 v[100:103], a[116:119], v[192:195], v[100:103]
  s_waitcnt vmcnt(1)
  v_max3_u32 v30, v196, v200, v200
  v_cmp_eq_u32 vcc, -1, v30
  v_mfma_f32_16x16x32_bf16 v[104:107], a[120:123], v[192:195], v[104:107]
  v_cvt_pk_bf16_f32 v33, v114, v115
  v_cvt_pk_bf16_f32 v34, v116, v117
  v_mfma_f32_16x16x32_bf16 v[108:111], a[124:127], v[192:195], v[108:111]
  s_cbranch_vccnz Lretry58
Lcont59:
  v_cvt_pk_bf16_f32 v35, v118, v119
  v_mfma_f32_16x16x32_bf16 v[96:99], a[128:131], v[196:199], v[96:99]
  buffer_store_dwordx4 v[32:35], v16, s[32:35], s68 offen sc1
  v_mfma_f32_16x16x32_bf16 v[100:103], a[132:135], v[196:199], v[100:103]
  v_mfma_f32_16x16x32_bf16 v[104:107], a[136:139], v[196:199], v[104:107]
  v_mfma_f32_16x16x32_bf16 v[108:111], a[140:143], v[196:199], v[108:111]
  v_mfma_f32_16x16x32_bf16 v[96:99], a[144:147], v[200:203], v[96:99]
  v_mfma_f32_16x16x32_bf16 v[100:103], a[148:151], v[200:203], v[100:103]
  s_waitcnt vmcnt(1)
  v_cmp_eq_u32 vcc, -1, v204
  v_mfma_f32_16x16x32_bf16 v[104:107], a[152:155], v[200:203], v[104:107]
  v_mfma_f32_16x16x32_bf16 v[108:111], a[156:159], v[200:203], v[108:111]
  s_cbranch_vccnz Lretry60
Lcont61:
  v_mfma_f32_16x16x32_bf16 v[96:99], a[160:163], v[204:207], v[96:99]
  v_mfma_f32_16x16x32_bf16 v[100:103], a[164:167], v[204:207], v[100:103]
  v_mfma_f32_16x16x32_bf16 v[104:107], a[168:171], v[204:207], v[104:107]
  v_mfma_f32_16x16x32_bf16 v[108:111], a[172:175], v[204:207], v[108:111]
  s_nop 4
  ds_write_b128 v8, v[96:99] offset:55296
  ds_write_b128 v8, v[100:103] offset:56448
  ds_write_b128 v8, v[104:107] offset:57600
  ds_write_b128 v8, v[108:111] offset:58752
  s_waitcnt lgkmcnt(0)
  s_barrier
  ds_read_b128 v[112:115], v9 offset:36864
  ds_read_b128 v[116:119], v9 offset:37152
  ds_read_b128 v[120:123], v9 offset:41472
  ds_read_b128 v[124:127], v9 offset:41760
  ds_read_b128 v[128:131], v9 offset:46080
  ds_read_b128 v[132:135], v9 offset:46368
  ds_read_b128 v[136:139], v9 offset:50688
  ds_read_b128 v[140:143], v9 offset:50976
  s_waitcnt lgkmcnt(4)
  v_pk_add_f32 v[112:113], v[112:113], v[120:121]
  v_pk_add_f32 v[114:115], v[114:115], v[122:123]
  v_pk_add_f32 v[116:117], v[116:117], v[124:125]
  v_pk_add_f32 v[118:119], v[118:119], v[126:127]
  s_waitcnt lgkmcnt(2)
  v_pk_add_f32 v[112:113], v[112:113], v[128:129]
  v_pk_add_f32 v[114:115], v[114:115], v[130:131]
  v_pk_add_f32 v[116:117], v[116:117], v[132:133]
  v_pk_add_f32 v[118:119], v[118:119], v[134:135]
  s_waitcnt lgkmcnt(0)
  v_pk_add_f32 v[112:113], v[112:113], v[136:137]
  v_pk_add_f32 v[114:115], v[114:115], v[138:139]
  v_pk_add_f32 v[116:117], v[116:117], v[140:141]
  v_pk_add_f32 v[118:119], v[118:119], v[142:143]
  v_cvt_pk_bf16_f32 v36, v112, v113
  v_cvt_pk_bf16_f32 v37, v114, v115
  v_cvt_pk_bf16_f32 v38, v116, v117
  v_cvt_pk_bf16_f32 v39, v118, v119
  buffer_store_dwordx4 v[36:39], v16, s[32:35], s69 offen sc1
Lend:
  s_endpgm
Lretry2:
  s_add_u32 s70, s70, 1
  s_cmp_gt_u32 s70, 100000
  s_cbranch_scc1 Lcont3
  s_waitcnt lgkmcnt(0)
  s_mov_b32 s80, m0
  s_lshl_b32 s68, s4, 6
  s_mov_b32 s69, 1064960
  buffer_load_dwordx4 v[112:115], v2, s[8:11], s69 offen sc1
  s_mov_b32 s69, 2121728
  buffer_load_dwordx4 v[116:119], v2, s[8:11], s69 offen sc1
  s_mov_b32 s69, 3178496
  buffer_load_dwordx4 v[120:123], v2, s[8:11], s69 offen sc1
  s_mov_b32 s69, 4235264
  buffer_load_dwordx4 v[124:127], v2, s[8:11], s69 offen sc1
  s_mov_b32 m0, s80
  s_waitcnt vmcnt(0)
  v_xor_b32 v30, s7, v113
  v_bitop3_b32 v30, v30, s7, v117 bitop3:0xf6
  v_bitop3_b32 v30, v30, s7, v121 bitop3:0xf6
  v_bitop3_b32 v30, v30, s7, v125 bitop3:0xf6
  v_cmp_ne_u32 vcc, 0, v30
  s_cbranch_vccnz Lretry2
  s_branch Lcont3
Lretry6:
  s_add_u32 s70, s70, 1
  s_cmp_gt_u32 s70, 100000
  s_cbranch_scc1 Lcont7
  s_waitcnt lgkmcnt(0)
  s_mov_b32 s80, m0
  s_lshl_b32 s68, s4, 6
  s_add_u32 s69, s68, 1048576
  buffer_load_dwordx4 v[96:99], v2, s[8:11], s69 offen sc1
  s_add_u32 s69, s68, 2105344
  buffer_load_dwordx4 v[100:103], v2, s[8:11], s69 offen sc1
  s_add_u32 s69, s68, 3162112
  buffer_load_dwordx4 v[104:107], v2, s[8:11], s69 offen sc1
  s_add_u32 s69, s68, 4218880
  buffer_load_dwordx4 v[108:111], v2, s[8:11], s69 offen sc1
  s_mov_b32 s69, 1064960
  buffer_load_dwordx4 v[112:115], v2, s[8:11], s69 offen sc1
  s_mov_b32 s69, 2121728
  buffer_load_dwordx4 v[116:119], v2, s[8:11], s69 offen sc1
  s_mov_b32 s69, 3178496
  buffer_load_dwordx4 v[120:123], v2, s[8:11], s69 offen sc1
  s_mov_b32 s69, 4235264
  buffer_load_dwordx4 v[124:127], v2, s[8:11], s69 offen sc1
  s_mov_b32 m0, s80
  s_waitcnt vmcnt(0)
  v_xor_b32 v30, s7, v99
  v_bitop3_b32 v30, v30, s7, v103 bitop3:0xf6
  v_bitop3_b32 v30, v30, s7, v107 bitop3:0xf6
  v_bitop3_b32 v30, v30, s7, v111 bitop3:0xf6
  v_bitop3_b32 v30, v30, s7, v115 bitop3:0xf6
  v_bitop3_b32 v30, v30, s7, v119 bitop3:0xf6
  v_bitop3_b32 v30, v30, s7, v123 bitop3:0xf6
  v_bitop3_b32 v30, v30, s7, v127 bitop3:0xf6
  v_cmp_ne_u32 vcc, 0, v30
  s_cbranch_vccnz Lretry6
  s_branch Lcont7
Lretry9:
  s_add_u32 s70, s70, 1
  s_cmp_gt_u32 s70, 100000
  s_cbranch_scc1 Lcont10
  s_waitcnt lgkmcnt(0)
  s_mov_b32 s80, m0
  s_movk_i32 s0, 24576
  buffer_load_dword v56, v5, s[8:11], s0 offen sc1
  s_mov_b32 m0, s80
  s_waitcnt vmcnt(0)
  v_cmp_ne_u32 vcc, s7, v56
  s_cbranch_vccnz Lretry9
  s_branch Lcont10
Lretry13:
  s_add_u32 s70, s70, 1
  s_cmp_gt_u32 s70, 100000
  s_cbranch_scc1 Lcont14
  s_waitcnt lgkmcnt(0)
  s_mov_b32 s80, m0
  s_add_u32 m0, s64, 0
  s_add_u32 s1, s65, 0
  buffer_load_dwordx4 v26, s[8:11], s1 offen offset:0 sc1 lds
  buffer_load_dwordx4 v27, s[8:11], s1 offen offset:1024 sc1 lds
  buffer_load_dwordx4 v28, s[8:11], s1 offen offset:2048 sc1 lds
  buffer_load_dwordx4 v29, s[8:11], s1 offen offset:3072 sc1 lds
  s_add_u32 m0, s64, 16384
  s_add_u32 s1, s65, 67584
  buffer_load_dwordx4 v26, s[8:11], s1 offen offset:0 sc1 lds
  buffer_load_dwordx4 v27, s[8:11], s1 offen offset:1024 sc1 lds
  buffer_load_dwordx4 v28, s[8:11], s1 offen offset:2048 sc1 lds
  buffer_load_dwordx4 v29, s[8:11], s1 offen offset:3072 sc1 lds
  s_mov_b32 m0, s80
  s_waitcnt vmcnt(0)
  ds_read_b64 v[112:113], v17 offset:0
  ds_read_b64 v[114:115], v17 offset:1024
  ds_read_b64 v[116:117], v17 offset:2048
  ds_read_b64 v[118:119], v17 offset:3072
  s_waitcnt lgkmcnt(0)
  v_max3_u32 v30, v112, v114, v116
  v_max_u32 v30, v30, v118
  v_cmp_eq_u32 vcc, -1, v30
  s_cbranch_vccnz Lretry13
  s_branch Lcont14
Lretry15:
  s_add_u32 s70, s70, 1
  s_cmp_gt_u32 s70, 100000
  s_cbranch_scc1 Lcont16
  s_waitcnt lgkmcnt(0)
  s_mov_b32 s80, m0
  s_add_u32 m0, s64, 16384
  s_add_u32 s1, s65, 67584
  buffer_load_dwordx4 v26, s[8:11], s1 offen offset:0 sc1 lds
  buffer_load_dwordx4 v27, s[8:11], s1 offen offset:1024 sc1 lds
  buffer_load_dwordx4 v28, s[8:11], s1 offen offset:2048 sc1 lds
  buffer_load_dwordx4 v29, s[8:11], s1 offen offset:3072 sc1 lds
  s_add_u32 m0, s64, 32768
  s_add_u32 s1, s65, 135168
  buffer_load_dwordx4 v26, s[8:11], s1 offen offset:0 sc1 lds
  buffer_load_dwordx4 v27, s[8:11], s1 offen offset:1024 sc1 lds
  buffer_load_dwordx4 v28, s[8:11], s1 offen offset:2048 sc1 lds
  buffer_load_dwordx4 v29, s[8:11], s1 offen offset:3072 sc1 lds
  s_add_u32 m0, s64, 49152
  s_add_u32 s1, s65, 202752
  buffer_load_dwordx4 v26, s[8:11], s1 offen offset:0 sc1 lds
  buffer_load_dwordx4 v27, s[8:11], s1 offen offset:1024 sc1 lds
  buffer_load_dwordx4 v28, s[8:11], s1 offen offset:2048 sc1 lds
  buffer_load_dwordx4 v29, s[8:11], s1 offen offset:3072 sc1 lds
  s_mov_b32 m0, s80
  s_waitcnt vmcnt(0)
  ds_read_b64 v[112:113], v17 offset:16384
  ds_read_b64 v[114:115], v17 offset:17408
  ds_read_b64 v[116:117], v17 offset:18432
  ds_read_b64 v[118:119], v17 offset:19456
  s_waitcnt lgkmcnt(0)
  v_max3_u32 v30, v112, v114, v116
  v_max_u32 v30, v30, v118
  v_cmp_eq_u32 vcc, -1, v30
  s_cbranch_vccnz Lretry15
  s_branch Lcont16
Lretry17:
  s_add_u32 s70, s70, 1
  s_cmp_gt_u32 s70, 100000
  s_cbranch_scc1 Lcont18
  s_waitcnt lgkmcnt(0)
  s_mov_b32 s80, m0
  s_add_u32 m0, s64, 32768
  s_add_u32 s1, s65, 135168
  buffer_load_dwordx4 v26, s[8:11], s1 offen offset:0 sc1 lds
  buffer_load_dwordx4 v27, s[8:11], s1 offen offset:1024 sc1 lds
  buffer_load_dwordx4 v28, s[8:11], s1 offen offset:2048 sc1 lds
  buffer_load_dwordx4 v29, s[8:11], s1 offen offset:3072 sc1 lds
  s_add_u32 m0, s64, 49152
  s_add_u32 s1, s65, 202752
  buffer_load_dwordx4 v26, s[8:11], s1 offen offset:0 sc1 lds
  buffer_load_dwordx4 v27, s[8:11], s1 offen offset:1024 sc1 lds
  buffer_load_dwordx4 v28, s[8:11], s1 offen offset:2048 sc1 lds
  buffer_load_dwordx4 v29, s[8:11], s1 offen offset:3072 sc1 lds
  s_mov_b32 m0, s80
  s_waitcnt vmcnt(0)
  ds_read_b64 v[112:113], v17 offset:32768
  ds_read_b64 v[114:115], v17 offset:33792
  ds_read_b64 v[116:117], v17 offset:34816
  ds_read_b64 v[118:119], v17 offset:35840
  s_waitcnt lgkmcnt(0)
  v_max3_u32 v30, v112, v114, v116
  v_max_u32 v30, v30, v118
  v_cmp_eq_u32 vcc, -1, v30
  s_cbranch_vccnz Lretry17
  s_branch Lcont18
Lretry19:
  s_add_u32 s70, s70, 1
  s_cmp_gt_u32 s70, 100000
  s_cbranch_scc1 Lcont20
  s_waitcnt lgkmcnt(0)
  s_mov_b32 s80, m0
  s_add_u32 m0, s64, 49152
  s_add_u32 s1, s65, 202752
  buffer_load_dwordx4 v26, s[8:11], s1 offen offset:0 sc1 lds
  buffer_load_dwordx4 v27, s[8:11], s1 offen offset:1024 sc1 lds
  buffer_load_dwordx4 v28, s[8:11], s1 offen offset:2048 sc1 lds
  buffer_load_dwordx4 v29, s[8:11], s1 offen offset:3072 sc1 lds
  s_mov_b32 m0, s80
  s_waitcnt vmcnt(0)
  ds_read_b64 v[112:113], v17 offset:49152
  ds_read_b64 v[114:115], v17 offset:50176
  ds_read_b64 v[116:117], v17 offset:51200
  ds_read_b64 v[118:119], v17 offset:52224
  s_waitcnt lgkmcnt(0)
  v_max3_u32 v30, v112, v114, v116
  v_max_u32 v30, v30, v118
  v_cmp_eq_u32 vcc, -1, v30
  s_cbranch_vccnz Lretry19
  s_branch Lcont20
Lretry21:
  s_add_u32 s70, s70, 1
  s_cmp_gt_u32 s70, 100000
  s_cbranch_scc1 Lcont22
  s_waitcnt lgkmcnt(0)
  s_mov_b32 s80, m0
  s_add_u32 s65, s64, 0
  buffer_load_dwordx4 v[64:67], v26, s[8:11], s65 offen sc1
  s_add_u32 s65, s64, 33024
  buffer_load_dwordx4 v[68:71], v26, s[8:11], s65 offen sc1
  s_add_u32 s65, s64, 66048
  buffer_load_dwordx4 v[72:75], v26, s[8:11], s65 offen sc1
  s_add_u32 s65, s64, 99072
  buffer_load_dwordx4 v[76:79], v26, s[8:11], s65 offen sc1
  s_add_u32 s65, s64, 132096
  buffer_load_dwordx4 v[80:83], v27, s[8:11], s65 offen sc1
  s_add_u32 s65, s64, 165120
  buffer_load_dwordx4 v[84:87], v27, s[8:11], s65 offen sc1
  s_add_u32 s65, s64, 198144
  buffer_load_dwordx4 v[88:91], v27, s[8:11], s65 offen sc1
  s_add_u32 s65, s64, 231168
  buffer_load_dwordx4 v[92:95], v27, s[8:11], s65 offen sc1
  s_add_u32 s65, s64, 264192
  buffer_load_dwordx4 v[96:99], v28, s[8:11], s65 offen sc1
  s_add_u32 s65, s64, 297216
  buffer_load_dwordx4 v[100:103], v28, s[8:11], s65 offen sc1
  s_add_u32 s65, s64, 330240
  buffer_load_dwordx4 v[104:107], v28, s[8:11], s65 offen sc1
  s_add_u32 s65, s64, 363264
  buffer_load_dwordx4 v[108:111], v28, s[8:11], s65 offen sc1
  s_add_u32 s65, s64, 396288
  buffer_load_dwordx4 v[112:115], v29, s[8:11], s65 offen sc1
  s_add_u32 s65, s64, 429312
  buffer_load_dwordx4 v[116:119], v29, s[8:11], s65 offen sc1
  s_add_u32 s65, s64, 462336
  buffer_load_dwordx4 v[120:123], v29, s[8:11], s65 offen sc1
  s_add_u32 s65, s64, 495360
  buffer_load_dwordx4 v[124:127], v29, s[8:11], s65 offen sc1
  s_mov_b32 m0, s80
  s_waitcnt vmcnt(0)
  v_max3_u32 v48, v65, v69, v73
  v_max_u32 v48, v48, v77
  v_cmp_eq_u32 vcc, -1, v48
  s_cbranch_vccnz Lretry21
  s_branch Lcont22
Lretry23:
  s_add_u32 s70, s70, 1
  s_cmp_gt_u32 s70, 100000
  s_cbranch_scc1 Lcont24
  s_waitcnt lgkmcnt(0)
  s_mov_b32 s80, m0
  s_add_u32 s65, s64, 132096
  buffer_load_dwordx4 v[80:83], v27, s[8:11], s65 offen sc1
  s_add_u32 s65, s64, 165120
  buffer_load_dwordx4 v[84:87], v27, s[8:11], s65 offen sc1
  s_add_u32 s65, s64, 198144
  buffer_load_dwordx4 v[88:91], v27, s[8:11], s65 offen sc1
  s_add_u32 s65, s64, 231168
  buffer_load_dwordx4 v[92:95], v27, s[8:11], s65 offen sc1
  s_add_u32 s65, s64, 264192
  buffer_load_dwordx4 v[96:99], v28, s[8:11], s65 offen sc1
  s_add_u32 s65, s64, 297216
  buffer_load_dwordx4 v[100:103], v28, s[8:11], s65 offen sc1
  s_add_u32 s65, s64, 330240
  buffer_load_dwordx4 v[104:107], v28, s[8:11], s65 offen sc1
  s_add_u32 s65, s64, 363264
  buffer_load_dwordx4 v[108:111], v28, s[8:11], s65 offen sc1
  s_add_u32 s65, s64, 396288
  buffer_load_dwordx4 v[112:115], v29, s[8:11], s65 offen sc1
  s_add_u32 s65, s64, 429312
  buffer_load_dwordx4 v[116:119], v29, s[8:11], s65 offen sc1
  s_add_u32 s65, s64, 462336
  buffer_load_dwordx4 v[120:123], v29, s[8:11], s65 offen sc1
  s_add_u32 s65, s64, 495360
  buffer_load_dwordx4 v[124:127], v29, s[8:11], s65 offen sc1
  s_mov_b32 m0, s80
  s_waitcnt vmcnt(0)
  v_max3_u32 v48, v81, v85, v89
  v_max_u32 v48, v48, v93
  v_cmp_eq_u32 vcc, -1, v48
  s_cbranch_vccnz Lretry23
  s_branch Lcont24
Lretry25:
  s_add_u32 s70, s70, 1
  s_cmp_gt_u32 s70, 100000
  s_cbranch_scc1 Lcont26
  s_waitcnt lgkmcnt(0)
  s_mov_b32 s80, m0
  s_add_u32 s65, s64, 264192
  buffer_load_dwordx4 v[96:99], v28, s[8:11], s65 offen sc1
  s_add_u32 s65, s64, 297216
  buffer_load_dwordx4 v[100:103], v28, s[8:11], s65 offen sc1
  s_add_u32 s65, s64, 330240
  buffer_load_dwordx4 v[104:107], v28, s[8:11], s65 offen sc1
  s_add_u32 s65, s64, 363264
  buffer_load_dwordx4 v[108:111], v28, s[8:11], s65 offen sc1
  s_add_u32 s65, s64, 396288
  buffer_load_dwordx4 v[112:115], v29, s[8:11], s65 offen sc1
  s_add_u32 s65, s64, 429312
  buffer_load_dwordx4 v[116:119], v29, s[8:11], s65 offen sc1
  s_add_u32 s65, s64, 462336
  buffer_load_dwordx4 v[120:123], v29, s[8:11], s65 offen sc1
  s_add_u32 s65, s64, 495360
  buffer_load_dwordx4 v[124:127], v29, s[8:11], s65 offen sc1
  s_mov_b32 m0, s80
  s_waitcnt vmcnt(0)
  v_max3_u32 v48, v97, v101, v105
  v_max_u32 v48, v48, v109
  v_cmp_eq_u32 vcc, -1, v48
  s_cbranch_vccnz Lretry25
  s_branch Lcont26
Lretry27:
  s_add_u32 s70, s70, 1
  s_cmp_gt_u32 s70, 100000
  s_cbranch_scc1 Lcont28
  s_waitcnt lgkmcnt(0)
  s_mov_b32 s80, m0
  s_add_u32 s65, s64, 396288
  buffer_load_dwordx4 v[112:115], v29, s[8:11], s65 offen sc1
  s_add_u32 s65, s64, 429312
  buffer_load_dwordx4 v[116:119], v29, s[8:11], s65 offen sc1
  s_add_u32 s65, s64, 462336
  buffer_load_dwordx4 v[120:123], v29, s[8:11], s65 offen sc1
  s_add_u32 s65, s64, 495360
  buffer_load_dwordx4 v[124:127], v29, s[8:11], s65 offen sc1
  s_mov_b32 m0, s80
  s_waitcnt vmcnt(0)
  v_max_u32 v48, v113, v117
  v_cmp_eq_u32 vcc, -1, v48
  s_cbranch_vccnz Lretry27
  s_branch Lcont28
Lretry29:
  s_add_u32 s70, s70, 1
  s_cmp_gt_u32 s70, 100000
  s_cbranch_scc1 Lcont30
  s_waitcnt lgkmcnt(0)
  s_mov_b32 s80, m0
  s_add_u32 s65, s64, 462336
  buffer_load_dwordx4 v[120:123], v29, s[8:11], s65 offen sc1
  s_add_u32 s65, s64, 495360
  buffer_load_dwordx4 v[124:127], v29, s[8:11], s65 offen sc1
  s_mov_b32 m0, s80
  s_waitcnt vmcnt(0)
  v_max_u32 v48, v121, v125
  v_cmp_eq_u32 vcc, -1, v48
  s_cbranch_vccnz Lretry29
  s_branch Lcont30
Lretry31:
  s_add_u32 s70, s70, 1
  s_cmp_gt_u32 s70, 100000
  s_cbranch_scc1 Lcont32
  s_waitcnt lgkmcnt(0)
  s_mov_b32 s80, m0
  buffer_load_dwordx4 v[116:119], v18, s[8:11], s69 offen offset:0 sc1
  buffer_load_dwordx4 v[120:123], v18, s[8:11], s69 offen offset:256 sc1
  s_mov_b32 m0, s80
  s_waitcnt vmcnt(0)
  v_xor_b32 v30, s7, v118
  v_bitop3_b32 v30, v30, s7, v122 bitop3:0xf6
  v_cmp_ne_u32 vcc, 0, v30
  s_cbranch_vccnz Lretry31
  s_branch Lcont32
Lretry33:
  s_add_u32 s70, s70, 1
  s_cmp_gt_u32 s70, 100000
  s_cbranch_scc1 Lcont34
  s_waitcnt lgkmcnt(0)
  s_mov_b32 s80, m0
  s_add_u32 m0, s64, 0
  s_add_u32 s1, s65, 0
  buffer_load_dwordx4 v31, s[8:11], s1 offen offset:0 sc1 lds
  buffer_load_dwordx4 v4, s[8:11], s1 offen offset:1024 sc1 lds
  buffer_load_dwordx4 v8, s[8:11], s1 offen offset:2048 sc1 lds
  buffer_load_dwordx4 v9, s[8:11], s1 offen offset:3072 sc1 lds
  s_add_u32 m0, s64, 16384
  s_add_u32 s1, s65, 256
  buffer_load_dwordx4 v31, s[8:11], s1 offen offset:0 sc1 lds
  buffer_load_dwordx4 v4, s[8:11], s1 offen offset:1024 sc1 lds
  buffer_load_dwordx4 v8, s[8:11], s1 offen offset:2048 sc1 lds
  buffer_load_dwordx4 v9, s[8:11], s1 offen offset:3072 sc1 lds
  s_mov_b32 m0, s80
  s_waitcnt vmcnt(0)
  ds_read_b64 v[100:101], v16 offset:0
  ds_read_b64 v[102:103], v16 offset:1024
  ds_read_b64 v[104:105], v16 offset:2048
  ds_read_b64 v[106:107], v16 offset:3072
  s_waitcnt lgkmcnt(0)
  v_max3_u32 v100, v101, v103, v105
  v_max_u32 v100, v100, v107
  v_cmp_eq_u32 vcc, -1, v100
  s_cbranch_vccnz Lretry33
  s_branch Lcont34
Lretry35:
  s_add_u32 s70, s70, 1
  s_cmp_gt_u32 s70, 100000
  s_cbranch_scc1 Lcont36
  s_waitcnt lgkmcnt(0)
  s_mov_b32 s80, m0
  s_add_u32 m0, s64, 16384
  s_add_u32 s1, s65, 256
  buffer_load_dwordx4 v31, s[8:11], s1 offen offset:0 sc1 lds
  buffer_load_dwordx4 v4, s[8:11], s1 offen offset:1024 sc1 lds
  buffer_load_dwordx4 v8, s[8:11], s1 offen offset:2048 sc1 lds
  buffer_load_dwordx4 v9, s[8:11], s1 offen offset:3072 sc1 lds
  s_add_u32 m0, s64, 32768
  s_add_u32 s1, s65, 512
  buffer_load_dwordx4 v31, s[8:11], s1 offen offset:0 sc1 lds
  buffer_load_dwordx4 v4, s[8:11], s1 offen offset:1024 sc1 lds
  buffer_load_dwordx4 v8, s[8:11], s1 offen offset:2048 sc1 lds
  buffer_load_dwordx4 v9, s[8:11], s1 offen offset:3072 sc1 lds
  s_add_u32 m0, s64, 49152
  s_add_u32 s1, s65, 768
  buffer_load_dwordx4 v31, s[8:11], s1 offen offset:0 sc1 lds
  buffer_load_dwordx4 v4, s[8:11], s1 offen offset:1024 sc1 lds
  buffer_load_dwordx4 v8, s[8:11], s1 offen offset:2048 sc1 lds
  buffer_load_dwordx4 v9, s[8:11], s1 offen offset:3072 sc1 lds
  s_mov_b32 m0, s80
  s_waitcnt vmcnt(0)
  ds_read_b64 v[100:101], v16 offset:16384
  ds_read_b64 v[102:103], v16 offset:17408
  ds_read_b64 v[104:105], v16 offset:18432
  ds_read_b64 v[106:107], v16 offset:19456
  s_waitcnt lgkmcnt(0)
  v_max3_u32 v100, v101, v103, v105
  v_max_u32 v100, v100, v107
  v_cmp_eq_u32 vcc, -1, v100
  s_cbranch_vccnz Lretry35
  s_branch Lcont36
Lretry37:
  s_add_u32 s70, s70, 1
  s_cmp_gt_u32 s70, 100000
  s_cbranch_scc1 Lcont38
  s_waitcnt lgkmcnt(0)
  s_mov_b32 s80, m0
  s_add_u32 m0, s64, 32768
  s_add_u32 s1, s65, 512
  buffer_load_dwordx4 v31, s[8:11], s1 offen offset:0 sc1 lds
  buffer_load_dwordx4 v4, s[8:11], s1 offen offset:1024 sc1 lds
  buffer_load_dwordx4 v8, s[8:11], s1 offen offset:2048 sc1 lds
  buffer_load_dwordx4 v9, s[8:11], s1 offen offset:3072 sc1 lds
  s_add_u32 m0, s64, 49152
  s_add_u32 s1, s65, 768
  buffer_load_dwordx4 v31, s[8:11], s1 offen offset:0 sc1 lds
  buffer_load_dwordx4 v4, s[8:11], s1 offen offset:1024 sc1 lds
  buffer_load_dwordx4 v8, s[8:11], s1 offen offset:2048 sc1 lds
  buffer_load_dwordx4 v9, s[8:11], s1 offen offset:3072 sc1 lds
  s_mov_b32 m0, s80
  s_waitcnt vmcnt(0)
  ds_read_b64 v[100:101], v16 offset:32768
  ds_read_b64 v[102:103], v16 offset:33792
  ds_read_b64 v[104:105], v16 offset:34816
  ds_read_b64 v[106:107], v16 offset:35840
  s_waitcnt lgkmcnt(0)
  v_max3_u32 v100, v101, v103, v105
  v_max_u32 v100, v100, v107
  v_cmp_eq_u32 vcc, -1, v100
  s_cbranch_vccnz Lretry37
  s_branch Lcont38
Lretry39:
  s_add_u32 s70, s70, 1
  s_cmp_gt_u32 s70, 100000
  s_cbranch_scc1 Lcont40
  s_waitcnt lgkmcnt(0)
  s_mov_b32 s80, m0
  s_add_u32 m0, s64, 49152
  s_add_u32 s1, s65, 768
  buffer_load_dwordx4 v31, s[8:11], s1 offen offset:0 sc1 lds
  buffer_load_dwordx4 v4, s[8:11], s1 offen offset:1024 sc1 lds
  buffer_load_dwordx4 v8, s[8:11], s1 offen offset:2048 sc1 lds
  buffer_load_dwordx4 v9, s[8:11], s1 offen offset:3072 sc1 lds
  s_mov_b32 m0, s80
  s_waitcnt vmcnt(0)
  ds_read_b64 v[100:101], v16 offset:49152
  ds_read_b64 v[102:103], v16 offset:50176
  ds_read_b64 v[104:105], v16 offset:51200
  ds_read_b64 v[106:107], v16 offset:52224
  s_waitcnt lgkmcnt(0)
  v_max3_u32 v100, v101, v103, v105
  v_max_u32 v100, v100, v107
  v_cmp_eq_u32 vcc, -1, v100
  s_cbranch_vccnz Lretry39
  s_branch Lcont40
Lretry41:
  s_add_u32 s70, s70, 1
  s_cmp_gt_u32 s70, 100000
  s_cbranch_scc1 Lcont42
  s_waitcnt lgkmcnt(0)
  s_mov_b32 s80, m0
  buffer_load_dword v24, v25, s[8:11], s78 offen sc1
  s_mov_b32 m0, s80
  s_waitcnt vmcnt(0)
  v_cmp_ne_u32 vcc, s7, v24
  s_cbranch_vccnz Lretry41
  s_branch Lcont42
Lretry44:
  s_add_u32 s70, s70, 1
  s_cmp_gt_u32 s70, 100000
  s_cbranch_scc1 Lcont45
  s_waitcnt lgkmcnt(0)
  s_mov_b32 s80, m0
  buffer_load_dwordx4 v[232:235], v2, s[8:11], s36 offen offset:512 sc1
  buffer_load_dwordx4 v[236:239], v2, s[8:11], s37 offen offset:512 sc1
  buffer_load_dwordx4 v[240:243], v2, s[8:11], s38 offen offset:512 sc1
  s_mov_b32 m0, s80
  s_waitcnt vmcnt(0)
  v_max3_u32 v30, v232, v236, v240
  v_cmp_eq_u32 vcc, -1, v30
  s_cbranch_vccnz Lretry44
  s_branch Lcont45
Lretry46:
  s_add_u32 s70, s70, 1
  s_cmp_gt_u32 s70, 100000
  s_cbranch_scc1 Lcont47
  s_waitcnt lgkmcnt(0)
  s_mov_b32 s80, m0
  buffer_load_dwordx4 v[244:247], v2, s[8:11], s39 offen offset:512 sc1
  buffer_load_dwordx4 v[248:251], v2, s[8:11], s40 offen offset:512 sc1
  buffer_load_dwordx4 v[252:255], v2, s[8:11], s41 offen offset:512 sc1
  s_mov_b32 m0, s80
  s_waitcnt vmcnt(0)
  v_max3_u32 v30, v244, v248, v252
  v_cmp_eq_u32 vcc, -1, v30
  s_cbranch_vccnz Lretry46
  s_branch Lcont47
Lretry48:
  s_add_u32 s70, s70, 1
  s_cmp_gt_u32 s70, 100000
  s_cbranch_scc1 Lcont49
  s_waitcnt lgkmcnt(0)
  s_mov_b32 s80, m0
  buffer_load_dwordx4 v[144:147], v2, s[8:11], s42 offen offset:512 sc1
  buffer_load_dwordx4 v[148:151], v2, s[8:11], s43 offen offset:512 sc1
  buffer_load_dwordx4 v[152:155], v2, s[8:11], s44 offen offset:512 sc1
  s_mov_b32 m0, s80
  s_waitcnt vmcnt(0)
  v_max3_u32 v30, v144, v148, v152
  v_cmp_eq_u32 vcc, -1, v30
  s_cbranch_vccnz Lretry48
  s_branch Lcont49
Lretry50:
  s_add_u32 s70, s70, 1
  s_cmp_gt_u32 s70, 100000
  s_cbranch_scc1 Lcont51
  s_waitcnt lgkmcnt(0)
  s_mov_b32 s80, m0
  buffer_load_dwordx4 v[156:159], v2, s[8:11], s45 offen offset:512 sc1
  buffer_load_dwordx4 v[160:163], v4, s[8:11], s46 offen offset:512 sc1
  s_mov_b32 m0, s80
  s_waitcnt vmcnt(0)
  v_max3_u32 v30, v156, v160, v160
  v_cmp_eq_u32 vcc, -1, v30
  s_cbranch_vccnz Lretry50
  s_branch Lcont51
Lretry52:
  s_add_u32 s70, s70, 1
  s_cmp_gt_u32 s70, 100000
  s_cbranch_scc1 Lcont53
  s_waitcnt lgkmcnt(0)
  s_mov_b32 s80, m0
  buffer_load_dwordx4 v[164:167], v2, s[8:11], s36 offen offset:768 sc1
  buffer_load_dwordx4 v[168:171], v2, s[8:11], s37 offen offset:768 sc1
  buffer_load_dwordx4 v[172:175], v2, s[8:11], s38 offen offset:768 sc1
  s_mov_b32 m0, s80
  s_waitcnt vmcnt(0)
  v_max3_u32 v30, v164, v168, v172
  v_cmp_eq_u32 vcc, -1, v30
  s_cbranch_vccnz Lretry52
  s_branch Lcont53
Lretry54:
  s_add_u32 s70, s70, 1
  s_cmp_gt_u32 s70, 100000
  s_cbranch_scc1 Lcont55
  s_waitcnt lgkmcnt(0)
  s_mov_b32 s80, m0
  buffer_load_dwordx4 v[176:179], v2, s[8:11], s39 offen offset:768 sc1
  buffer_load_dwordx4 v[180:183], v2, s[8:11], s40 offen offset:768 sc1
  buffer_load_dwordx4 v[184:187], v2, s[8:11], s41 offen offset:768 sc1
  s_mov_b32 m0, s80
  s_waitcnt vmcnt(0)
  v_max3_u32 v30, v176, v180, v184
  v_cmp_eq_u32 vcc, -1, v30
  s_cbranch_vccnz Lretry54
  s_branch Lcont55
Lretry56:
  s_add_u32 s70, s70, 1
  s_cmp_gt_u32 s70, 100000
  s_cbranch_scc1 Lcont57
  s_waitcnt lgkmcnt(0)
  s_mov_b32 s80, m0
  buffer_load_dwordx4 v[188:191], v2, s[8:11], s42 offen offset:768 sc1
  buffer_load_dwordx4 v[192:195], v2, s[8:11], s43 offen offset:768 sc1
  s_mov_b32 m0, s80
  s_waitcnt vmcnt(0)
  v_max3_u32 v30, v188, v192, v192
  v_cmp_eq_u32 vcc, -1, v30
  s_cbranch_vccnz Lretry56
  s_branch Lcont57
Lretry58:
  s_add_u32 s70, s70, 1
  s_cmp_gt_u32 s70, 100000
  s_cbranch_scc1 Lcont59
  s_waitcnt lgkmcnt(0)
  s_mov_b32 s80, m0
  buffer_load_dwordx4 v[196:199], v2, s[8:11], s44 offen offset:768 sc1
  buffer_load_dwordx4 v[200:203], v2, s[8:11], s45 offen offset:768 sc1
  s_mov_b32 m0, s80
  s_waitcnt vmcnt(0)
  v_max3_u32 v30, v196, v200, v200
  v_cmp_eq_u32 vcc, -1, v30
  s_cbranch_vccnz Lretry58
  s_branch Lcont59
Lretry60:
  s_add_u32 s70, s70, 1
  s_cmp_gt_u32 s70, 100000
  s_cbranch_scc1 Lcont61
  s_waitcnt lgkmcnt(0)
  s_mov_b32 s80, m0
  buffer_load_dwordx4 v[204:207], v4, s[8:11], s46 offen offset:768 sc1
  s_mov_b32 m0, s80
  s_waitcnt vmcnt(0)
  v_cmp_eq_u32 vcc, -1, v204
  s_cbranch_vccnz Lretry60
  s_branch Lcont61
Lcode_end:
.section .rodata,"a"
.p2align 6
.amdhsa_kernel sequential_preLN__ssm_conv_s4d__mixer_s_mlp__prompt_kernel
  .amdhsa_next_free_vgpr 512
  .amdhsa_next_free_sgpr 102
  .amdhsa_accum_offset 256
  .amdhsa_group_segment_fixed_size 0
  .amdhsa_kernarg_size 120
  .amdhsa_user_sgpr_count 2
  .amdhsa_user_sgpr_kernarg_segment_ptr 1
  .amdhsa_system_sgpr_workgroup_id_x 1
.end_amdhsa_kernel
```
